```python
import torch

def _softmax(x, axis=-1):
    return torch.softmax(x, dim=axis)
def _gelu(x):
    return torch.nn.functional.gelu(x, approximate="tanh")
def _silu(x):
    return torch.nn.functional.silu(x)
def _sigmoid(x):
    return torch.sigmoid(x)
def _layernorm(x, axis=-1, eps=1e-5):
    m = x.mean(dim=axis, keepdim=True)
    v = x.var(dim=axis, keepdim=True, unbiased=False)
    return (x - m) / torch.sqrt(v + eps)
def _scatter_add(tgt, idx, src, axis=0):
    return tgt.clone().index_add_(axis, idx, src)
def _segment_sum(src, seg, n):
    out = torch.zeros((n,) + src.shape[1:], dtype=src.dtype)
    return out.index_add_(0, seg, src)
def _pad(x, pw):
    flat = tuple(v for pair in reversed(pw) for v in pair)
    return torch.nn.functional.pad(x, flat)

kernel_name = 'gated_mix__softmax_full_mha__grouped_kv_mqa__prompt'

def setup_inputs():

    _w = (lambda a: (lambda t: t.to(torch.bfloat16) if t.is_floating_point() else t)(torch.as_tensor(a)))
    def _A_setup():
        B, S, D = 1, 2048, 576
        return {
            "x": _w((lambda *s: torch.randn(*s, dtype=torch.bfloat16) * 0.1)(B, S, D)),
            "wqkv": _w((lambda *s: torch.randn(*s, dtype=torch.bfloat16) * 0.4)(D, 3 * D)),
            "wo": _w((lambda *s: torch.randn(*s, dtype=torch.bfloat16) * 0.2)(D, D)),
        }
    _A_in = _A_setup()

    def _B_setup():
        B, S, D, H = 1, 2048, 576, 32
        Dh = D // H
        return {
            "x": _w((lambda *s: torch.randn(*s, dtype=torch.bfloat16) * 0.1)(B, S, D)),
            "wq": _w((lambda *s: torch.randn(*s, dtype=torch.bfloat16) * 0.4)(D, H * Dh)),
            "wk": _w((lambda *s: torch.randn(*s, dtype=torch.bfloat16) * 0.4)(D, Dh)),
            "wv": _w((lambda *s: torch.randn(*s, dtype=torch.bfloat16) * 0.4)(D, Dh)),
            "wo": _w((lambda *s: torch.randn(*s, dtype=torch.bfloat16) * 0.4)(H * Dh, D)),
        }
    _B_in = _B_setup()

    return {
        "A_x": _A_in["x"],
        "A_wqkv": _A_in["wqkv"],
        "A_wo": _A_in["wo"],
        "B_x": _B_in["x"],
        "B_wq": _B_in["wq"],
        "B_wk": _B_in["wk"],
        "B_wv": _B_in["wv"],
        "B_wo": _B_in["wo"],
        "gate_w": _w((lambda *s: torch.randn(*s, dtype=torch.bfloat16) * 0.1)(576) * 16.0),
    }

def reference(A_x, A_wqkv, A_wo, B_x, B_wq, B_wk, B_wv, B_wo, gate_w):
    def _A_ref(x, wqkv, wo):
        B, S, D = x.shape
        H = 32; Dh = D // H
        qkv = (lambda x, *d: x.permute(*d))((x @ wqkv).reshape(B, S, 3, H, Dh), 2, 0, 3, 1, 4)
        q, k, v = qkv[0], qkv[1], qkv[2]
        scale = Dh ** -0.5
        scores = torch.einsum("bhqd,bhkd->bhqk", q, k) * scale
        p = _softmax(scores, axis=-1)
        o = torch.einsum("bhqk,bhkd->bhqd", p, v)
        return (lambda x, *d: x.permute(*d))(o, 0, 2, 1, 3).reshape(B, S, D) @ wo

    def _B_ref(x, wq, wk, wv, wo):
        B, S, D = x.shape
        H = 32
        Dh = D // H
        q = (lambda x, *d: x.permute(*d))((x @ wq).reshape(B, S, H, Dh), 0, 2, 1, 3)
        k = x @ wk
        v = x @ wv
        scores = torch.einsum("bhqd,bkd->bhqk", q, k) * (Dh ** -0.5)
        p = _softmax(scores, axis=-1)
        o = torch.einsum("bhqk,bkd->bhqd", p, v)
        return (lambda x, *d: x.permute(*d))(o, 0, 2, 1, 3).reshape(B, S, H * Dh) @ wo

    x = A_x
    g = _sigmoid((x * gate_w).sum(-1, keepdims=True))
    a = _A_ref(x, A_wqkv, A_wo)
    b = _B_ref(x, B_wq, B_wk, B_wv, B_wo)
    return g * a + (1 - g) * b
```

```asm
; @launch kernel=proj_kernel grid=(256,1,1) block=(512,1,1) lds=147456
; @launch kernel=attn_kernel grid=(256,1,1) block=(576,1,1) lds=163840
.amdgcn_target "amdgcn-amd-amdhsa--gfx950"
.text
.globl proj_kernel
.p2align 8
.type proj_kernel,@function
proj_kernel:
    s_load_dwordx4 s[4:7], s[0:1], 0
    s_load_dwordx4 s[8:11], s[0:1], 32
    s_load_dwordx2 s[12:13], s[0:1], 48
    s_load_dwordx2 s[14:15], s[0:1], 64
    s_load_dwordx2 s[16:17], s[0:1], 88

    s_cmp_ge_u32 s2, 256
    s_cbranch_scc1 L1_end
    s_getpc_b64 s[46:47]
L1_pc0:
    s_and_b32 s44, s2, 0xf8
    s_lshl_b32 s44, s44, 8
    v_lshlrev_b32 v2, 2, v0
    v_and_b32 v2, 0x780, v2
    v_add_u32 v2, s44, v2
    v_min_u32 v2, L2_end-L1_pc0, v2
    v_mov_b32 v3, 0
    v_lshl_add_u64 v[2:3], v[2:3], 0, s[46:47]
    global_load_dword v250, v[2:3], off

    v_lshrrev_b32 v2, 6, v0
    v_and_b32 v1, 63, v0
    s_and_b32 s42, s2, 7
    v_readfirstlane_b32 s35, v2
    s_lshr_b32 s43, s2, 3
    s_and_b32 s32, s42, 1
    s_lshl_b32 s32, s32, 3
    s_and_b32 s44, s43, 7
    s_add_u32 s32, s32, s44
    s_lshr_b32 s34, s42, 1
    s_lshl_b32 s33, s34, 2
    s_lshr_b32 s45, s43, 3
    s_add_u32 s33, s33, s45
    s_lshr_b32 s45, s43, 3
    s_xor_b32 s35, s35, 4
    s_cmp_lt_u32 s35, 4
    s_cbranch_scc1 L1_consumer

    s_add_u32 s55, s44, s45
    s_mul_i32 s44, s55, 86
    s_lshr_b32 s44, s44, 8
    s_mul_i32 s44, s44, 3
    s_sub_u32 s55, s55, s44
    s_mul_i32 s55, s55, 3

    s_mov_b32 s56, s55
    s_sub_u32 s36, s35, 4
    s_and_b32 s37, s36, 1
    s_cmp_ge_u32 s36, 2
    s_cbranch_scc1 L1_xloader
    s_movk_i32 s38, 3456
    s_cmp_eq_u32 s34, 3
    s_cselect_b32 s38, 1152, s38
    s_lshl_b32 s39, s37, 5
    s_lshl_b32 s40, s38, 6
    s_cmp_eq_u32 s34, 3
    s_cselect_b32 s45, 12, 0
    s_sub_u32 s41, s33, s45
    s_mul_i32 s41, s41, 288
    s_mul_i32 s48, s37, 9216

    v_add_u32 v4, 0, v1
    v_mul_u32_u24 v5, 3641, v4
    v_lshrrev_b32 v5, 16, v5
    v_mul_u32_u24 v6, 18, v5
    v_sub_u32 v6, v4, v6
    v_and_b32 v7, 0x18, v5
    v_bfe_u32 v8, v5, 1, 2
    v_and_b32 v5, 1, v5
    v_lshl_or_b32 v5, v5, 2, v8
    v_add3_u32 v5, v5, v7, s39
    v_mul_u32_u24 v5, s38, v5
    v_lshl_add_u32 v10, v6, 4, v5

    v_add_u32 v4, 64, v1
    v_mul_u32_u24 v5, 3641, v4
    v_lshrrev_b32 v5, 16, v5
    v_mul_u32_u24 v6, 18, v5
    v_sub_u32 v6, v4, v6
    v_and_b32 v7, 0x18, v5
    v_bfe_u32 v8, v5, 1, 2
    v_and_b32 v5, 1, v5
    v_lshl_or_b32 v5, v5, 2, v8
    v_add3_u32 v5, v5, v7, s39
    v_mul_u32_u24 v5, s38, v5
    v_lshl_add_u32 v11, v6, 4, v5

    v_add_u32 v4, 128, v1
    v_mul_u32_u24 v5, 3641, v4
    v_lshrrev_b32 v5, 16, v5
    v_mul_u32_u24 v6, 18, v5
    v_sub_u32 v6, v4, v6
    v_and_b32 v7, 0x18, v5
    v_bfe_u32 v8, v5, 1, 2
    v_and_b32 v5, 1, v5
    v_lshl_or_b32 v5, v5, 2, v8
    v_add3_u32 v5, v5, v7, s39
    v_mul_u32_u24 v5, s38, v5
    v_lshl_add_u32 v12, v6, 4, v5

    s_waitcnt lgkmcnt(0)
    s_cmp_eq_u32 s34, 3
    s_cselect_b32 s20, s8, s6
    s_cselect_b32 s21, s9, s7
    s_mov_b32 s22, 1990656
    s_cselect_b32 s22, 663552, s22
    s_mov_b32 s23, 0x00020000

    s_mul_i32 s50, s55, s40
    s_add_u32 s50, s50, s41
    s_add_u32 m0, s48, 0
    s_add_u32 s55, s55, 1
    s_cmp_eq_u32 s55, 9
    s_cselect_b32 s55, 0, s55
    buffer_load_dwordx4 v10, s[20:23], s50 offen  lds
    s_add_u32 m0, s48, 1024
    s_nop 0
    buffer_load_dwordx4 v11, s[20:23], s50 offen  lds
    s_add_u32 m0, s48, 2048
    s_nop 0
    buffer_load_dwordx4 v12, s[20:23], s50 offen  lds
    v_add_u32 v4, 192, v1
    v_mul_u32_u24 v5, 3641, v4
    v_lshrrev_b32 v5, 16, v5
    v_mul_u32_u24 v6, 18, v5
    v_sub_u32 v6, v4, v6
    v_and_b32 v7, 0x18, v5
    v_bfe_u32 v8, v5, 1, 2
    v_and_b32 v5, 1, v5
    v_lshl_or_b32 v5, v5, 2, v8
    v_add3_u32 v5, v5, v7, s39
    v_mul_u32_u24 v5, s38, v5
    v_lshl_add_u32 v13, v6, 4, v5

    s_add_u32 m0, s48, 3072
    s_nop 0
    buffer_load_dwordx4 v13, s[20:23], s50 offen  lds
    v_add_u32 v4, 256, v1
    v_mul_u32_u24 v5, 3641, v4
    v_lshrrev_b32 v5, 16, v5
    v_mul_u32_u24 v6, 18, v5
    v_sub_u32 v6, v4, v6
    v_and_b32 v7, 0x18, v5
    v_bfe_u32 v8, v5, 1, 2
    v_and_b32 v5, 1, v5
    v_lshl_or_b32 v5, v5, 2, v8
    v_add3_u32 v5, v5, v7, s39
    v_mul_u32_u24 v5, s38, v5
    v_lshl_add_u32 v14, v6, 4, v5

    s_add_u32 m0, s48, 4096
    s_nop 0
    buffer_load_dwordx4 v14, s[20:23], s50 offen  lds
    v_add_u32 v4, 320, v1
    v_mul_u32_u24 v5, 3641, v4
    v_lshrrev_b32 v5, 16, v5
    v_mul_u32_u24 v6, 18, v5
    v_sub_u32 v6, v4, v6
    v_and_b32 v7, 0x18, v5
    v_bfe_u32 v8, v5, 1, 2
    v_and_b32 v5, 1, v5
    v_lshl_or_b32 v5, v5, 2, v8
    v_add3_u32 v5, v5, v7, s39
    v_mul_u32_u24 v5, s38, v5
    v_lshl_add_u32 v15, v6, 4, v5

    s_add_u32 m0, s48, 5120
    s_nop 0
    buffer_load_dwordx4 v15, s[20:23], s50 offen  lds
    v_add_u32 v4, 384, v1
    v_mul_u32_u24 v5, 3641, v4
    v_lshrrev_b32 v5, 16, v5
    v_mul_u32_u24 v6, 18, v5
    v_sub_u32 v6, v4, v6
    v_and_b32 v7, 0x18, v5
    v_bfe_u32 v8, v5, 1, 2
    v_and_b32 v5, 1, v5
    v_lshl_or_b32 v5, v5, 2, v8
    v_add3_u32 v5, v5, v7, s39
    v_mul_u32_u24 v5, s38, v5
    v_lshl_add_u32 v16, v6, 4, v5

    s_add_u32 m0, s48, 6144
    s_nop 0
    buffer_load_dwordx4 v16, s[20:23], s50 offen  lds
    v_add_u32 v4, 448, v1
    v_mul_u32_u24 v5, 3641, v4
    v_lshrrev_b32 v5, 16, v5
    v_mul_u32_u24 v6, 18, v5
    v_sub_u32 v6, v4, v6
    v_and_b32 v7, 0x18, v5
    v_bfe_u32 v8, v5, 1, 2
    v_and_b32 v5, 1, v5
    v_lshl_or_b32 v5, v5, 2, v8
    v_add3_u32 v5, v5, v7, s39
    v_mul_u32_u24 v5, s38, v5
    v_lshl_add_u32 v17, v6, 4, v5

    s_add_u32 m0, s48, 7168
    s_nop 0
    buffer_load_dwordx4 v17, s[20:23], s50 offen  lds
    v_add_u32 v4, 512, v1
    v_mul_u32_u24 v5, 3641, v4
    v_lshrrev_b32 v5, 16, v5
    v_mul_u32_u24 v6, 18, v5
    v_sub_u32 v6, v4, v6
    v_and_b32 v7, 0x18, v5
    v_bfe_u32 v8, v5, 1, 2
    v_and_b32 v5, 1, v5
    v_lshl_or_b32 v5, v5, 2, v8
    v_add3_u32 v5, v5, v7, s39
    v_mul_u32_u24 v5, s38, v5
    v_lshl_add_u32 v18, v6, 4, v5

    s_add_u32 m0, s48, 8192
    s_nop 0
    buffer_load_dwordx4 v18, s[20:23], s50 offen  lds
    s_mul_i32 s50, s55, s40
    s_add_u32 s50, s50, s41
    s_add_u32 m0, s48, 20480
    s_add_u32 s55, s55, 1
    s_cmp_eq_u32 s55, 9
    s_cselect_b32 s55, 0, s55
    buffer_load_dwordx4 v10, s[20:23], s50 offen  lds
    s_add_u32 m0, s48, 21504
    s_nop 0
    buffer_load_dwordx4 v11, s[20:23], s50 offen  lds
    s_add_u32 m0, s48, 22528
    s_nop 0
    buffer_load_dwordx4 v12, s[20:23], s50 offen  lds
    s_add_u32 m0, s48, 23552
    s_nop 0
    buffer_load_dwordx4 v13, s[20:23], s50 offen  lds
    s_add_u32 m0, s48, 24576
    s_nop 0
    buffer_load_dwordx4 v14, s[20:23], s50 offen  lds
    s_add_u32 m0, s48, 25600
    s_nop 0
    buffer_load_dwordx4 v15, s[20:23], s50 offen  lds
    s_add_u32 m0, s48, 26624
    s_nop 0
    buffer_load_dwordx4 v16, s[20:23], s50 offen  lds
    s_add_u32 m0, s48, 27648
    s_nop 0
    buffer_load_dwordx4 v17, s[20:23], s50 offen  lds
    s_add_u32 m0, s48, 28672
    s_nop 0
    buffer_load_dwordx4 v18, s[20:23], s50 offen  lds
    s_mov_b32 s28, s14
    s_mov_b32 s29, s15
    s_mov_b32 s30, 1152
    s_mov_b32 s31, 0x00020000
    s_mov_b32 s24, s16
    s_mov_b32 s25, s17
    s_mov_b32 s26, 15974528
    s_mov_b32 s27, 0x00020000
    v_and_b32 v2, 31, v1
    v_lshlrev_b32 v3, 2, v2
    s_lshl_b32 s50, s56, 7
    s_add_u32 s56, s56, 1
    s_cmp_eq_u32 s56, 9
    s_cselect_b32 s56, 0, s56
    buffer_load_dword v40, v3, s[28:31], s50 offen
    s_lshl_b32 s50, s56, 7
    s_add_u32 s56, s56, 1
    s_cmp_eq_u32 s56, 9
    s_cselect_b32 s56, 0, s56
    buffer_load_dword v41, v3, s[28:31], s50 offen
    s_lshl_b32 s50, s56, 7
    s_add_u32 s56, s56, 1
    s_cmp_eq_u32 s56, 9
    s_cselect_b32 s56, 0, s56
    buffer_load_dword v42, v3, s[28:31], s50 offen
    s_lshl_b32 s50, s56, 7
    s_add_u32 s56, s56, 1
    s_cmp_eq_u32 s56, 9
    s_cselect_b32 s56, 0, s56
    buffer_load_dword v43, v3, s[28:31], s50 offen
    s_lshl_b32 s50, s56, 7
    s_add_u32 s56, s56, 1
    s_cmp_eq_u32 s56, 9
    s_cselect_b32 s56, 0, s56
    buffer_load_dword v44, v3, s[28:31], s50 offen
    s_lshl_b32 s50, s56, 7
    s_add_u32 s56, s56, 1
    s_cmp_eq_u32 s56, 9
    s_cselect_b32 s56, 0, s56
    buffer_load_dword v45, v3, s[28:31], s50 offen
    s_lshl_b32 s50, s56, 7
    s_add_u32 s56, s56, 1
    s_cmp_eq_u32 s56, 9
    s_cselect_b32 s56, 0, s56
    buffer_load_dword v46, v3, s[28:31], s50 offen
    s_lshl_b32 s50, s56, 7
    s_add_u32 s56, s56, 1
    s_cmp_eq_u32 s56, 9
    s_cselect_b32 s56, 0, s56
    buffer_load_dword v47, v3, s[28:31], s50 offen
    s_lshl_b32 s50, s56, 7
    s_add_u32 s56, s56, 1
    s_cmp_eq_u32 s56, 9
    s_cselect_b32 s56, 0, s56
    buffer_load_dword v48, v3, s[28:31], s50 offen
    s_lshl_b32 s44, s33, 3
    s_lshl_b32 s45, s36, 1
    s_add_u32 s44, s44, s45
    v_lshrrev_b32 v4, 5, v1
    v_add_u32 v35, s44, v4
    v_lshrrev_b32 v5, 1, v35
    v_lshrrev_b32 v6, 2, v2
    v_xor_b32 v5, v5, v6
    v_and_b32 v5, 7, v5
    v_lshlrev_b32 v5, 4, v5
    v_and_b32 v6, 3, v1
    v_lshl_add_u32 v5, v6, 2, v5
    v_lshl_add_u32 v34, v35, 7, v5
    v_add_u32 v34, 81920, v34

    s_waitcnt vmcnt(18) lgkmcnt(0)
    s_barrier
    ds_read_b32 v50, v34 offset:0
    s_mul_i32 s50, s55, s40
    s_add_u32 s50, s50, s41
    s_add_u32 m0, s48, 40960
    s_add_u32 s55, s55, 1
    s_cmp_eq_u32 s55, 9
    s_cselect_b32 s55, 0, s55
    buffer_load_dwordx4 v10, s[20:23], s50 offen  lds
    s_add_u32 m0, s48, 41984
    s_nop 0
    buffer_load_dwordx4 v11, s[20:23], s50 offen  lds
    s_add_u32 m0, s48, 43008
    s_nop 0
    buffer_load_dwordx4 v12, s[20:23], s50 offen  lds
    s_add_u32 m0, s48, 44032
    s_nop 0
    buffer_load_dwordx4 v13, s[20:23], s50 offen  lds
    s_add_u32 m0, s48, 45056
    s_nop 0
    buffer_load_dwordx4 v14, s[20:23], s50 offen  lds
    s_add_u32 m0, s48, 46080
    s_nop 0
    buffer_load_dwordx4 v15, s[20:23], s50 offen  lds
    s_add_u32 m0, s48, 47104
    s_nop 0
    buffer_load_dwordx4 v16, s[20:23], s50 offen  lds
    s_add_u32 m0, s48, 48128
    s_nop 0
    buffer_load_dwordx4 v17, s[20:23], s50 offen  lds
    s_add_u32 m0, s48, 49152
    s_nop 0
    buffer_load_dwordx4 v18, s[20:23], s50 offen  lds
    s_waitcnt vmcnt(18) lgkmcnt(0)
    s_barrier
    ds_read_b32 v51, v34 offset:16384
    s_mul_i32 s50, s55, s40
    s_add_u32 s50, s50, s41
    s_add_u32 m0, s48, 61440
    s_add_u32 s55, s55, 1
    s_cmp_eq_u32 s55, 9
    s_cselect_b32 s55, 0, s55
    buffer_load_dwordx4 v10, s[20:23], s50 offen  lds
    s_add_u32 m0, s48, 62464
    s_nop 0
    buffer_load_dwordx4 v11, s[20:23], s50 offen  lds
    s_add_u32 m0, s48, 63488
    s_nop 0
    buffer_load_dwordx4 v12, s[20:23], s50 offen  lds
    s_add_u32 m0, s48, 64512
    s_nop 0
    buffer_load_dwordx4 v13, s[20:23], s50 offen  lds
    s_add_u32 m0, s48, 65536
    s_nop 0
    buffer_load_dwordx4 v14, s[20:23], s50 offen  lds
    s_add_u32 m0, s48, 66560
    s_nop 0
    buffer_load_dwordx4 v15, s[20:23], s50 offen  lds
    s_add_u32 m0, s48, 67584
    s_nop 0
    buffer_load_dwordx4 v16, s[20:23], s50 offen  lds
    s_add_u32 m0, s48, 68608
    s_nop 0
    buffer_load_dwordx4 v17, s[20:23], s50 offen  lds
    s_add_u32 m0, s48, 69632
    s_nop 0
    buffer_load_dwordx4 v18, s[20:23], s50 offen  lds
    s_waitcnt vmcnt(9) lgkmcnt(0)
    s_barrier
    ds_read_b32 v52, v34 offset:32768
    s_mul_i32 s50, s55, s40
    s_add_u32 s50, s50, s41
    s_add_u32 m0, s48, 0
    s_add_u32 s55, s55, 1
    s_cmp_eq_u32 s55, 9
    s_cselect_b32 s55, 0, s55
    buffer_load_dwordx4 v10, s[20:23], s50 offen  lds
    s_add_u32 m0, s48, 1024
    s_nop 0
    buffer_load_dwordx4 v11, s[20:23], s50 offen  lds
    s_add_u32 m0, s48, 2048
    s_nop 0
    buffer_load_dwordx4 v12, s[20:23], s50 offen  lds
    s_add_u32 m0, s48, 3072
    s_nop 0
    buffer_load_dwordx4 v13, s[20:23], s50 offen  lds
    s_add_u32 m0, s48, 4096
    s_nop 0
    buffer_load_dwordx4 v14, s[20:23], s50 offen  lds
    s_add_u32 m0, s48, 5120
    s_nop 0
    buffer_load_dwordx4 v15, s[20:23], s50 offen  lds
    s_add_u32 m0, s48, 6144
    s_nop 0
    buffer_load_dwordx4 v16, s[20:23], s50 offen  lds
    s_add_u32 m0, s48, 7168
    s_nop 0
    buffer_load_dwordx4 v17, s[20:23], s50 offen  lds
    s_add_u32 m0, s48, 8192
    s_nop 0
    buffer_load_dwordx4 v18, s[20:23], s50 offen  lds
    s_waitcnt vmcnt(9) lgkmcnt(0)
    s_barrier
    ds_read_b32 v53, v34 offset:49152
    s_mul_i32 s50, s55, s40
    s_add_u32 s50, s50, s41
    s_add_u32 m0, s48, 20480
    s_add_u32 s55, s55, 1
    s_cmp_eq_u32 s55, 9
    s_cselect_b32 s55, 0, s55
    buffer_load_dwordx4 v10, s[20:23], s50 offen  lds
    s_add_u32 m0, s48, 21504
    s_nop 0
    buffer_load_dwordx4 v11, s[20:23], s50 offen  lds
    s_add_u32 m0, s48, 22528
    s_nop 0
    buffer_load_dwordx4 v12, s[20:23], s50 offen  lds
    s_add_u32 m0, s48, 23552
    s_nop 0
    buffer_load_dwordx4 v13, s[20:23], s50 offen  lds
    s_add_u32 m0, s48, 24576
    s_nop 0
    buffer_load_dwordx4 v14, s[20:23], s50 offen  lds
    s_add_u32 m0, s48, 25600
    s_nop 0
    buffer_load_dwordx4 v15, s[20:23], s50 offen  lds
    s_add_u32 m0, s48, 26624
    s_nop 0
    buffer_load_dwordx4 v16, s[20:23], s50 offen  lds
    s_add_u32 m0, s48, 27648
    s_nop 0
    buffer_load_dwordx4 v17, s[20:23], s50 offen  lds
    s_add_u32 m0, s48, 28672
    s_nop 0
    buffer_load_dwordx4 v18, s[20:23], s50 offen  lds
    s_waitcnt vmcnt(9) lgkmcnt(0)
    s_barrier
    ds_read_b32 v54, v34 offset:0
    s_mul_i32 s50, s55, s40
    s_add_u32 s50, s50, s41
    s_add_u32 m0, s48, 40960
    s_add_u32 s55, s55, 1
    s_cmp_eq_u32 s55, 9
    s_cselect_b32 s55, 0, s55
    buffer_load_dwordx4 v10, s[20:23], s50 offen  lds
    s_add_u32 m0, s48, 41984
    s_nop 0
    buffer_load_dwordx4 v11, s[20:23], s50 offen  lds
    s_add_u32 m0, s48, 43008
    s_nop 0
    buffer_load_dwordx4 v12, s[20:23], s50 offen  lds
    s_add_u32 m0, s48, 44032
    s_nop 0
    buffer_load_dwordx4 v13, s[20:23], s50 offen  lds
    s_add_u32 m0, s48, 45056
    s_nop 0
    buffer_load_dwordx4 v14, s[20:23], s50 offen  lds
    s_add_u32 m0, s48, 46080
    s_nop 0
    buffer_load_dwordx4 v15, s[20:23], s50 offen  lds
    s_add_u32 m0, s48, 47104
    s_nop 0
    buffer_load_dwordx4 v16, s[20:23], s50 offen  lds
    s_add_u32 m0, s48, 48128
    s_nop 0
    buffer_load_dwordx4 v17, s[20:23], s50 offen  lds
    s_add_u32 m0, s48, 49152
    s_nop 0
    buffer_load_dwordx4 v18, s[20:23], s50 offen  lds
    s_waitcnt vmcnt(9) lgkmcnt(0)
    s_barrier
    ds_read_b32 v55, v34 offset:16384
    s_mul_i32 s50, s55, s40
    s_add_u32 s50, s50, s41
    s_add_u32 m0, s48, 61440
    s_add_u32 s55, s55, 1
    s_cmp_eq_u32 s55, 9
    s_cselect_b32 s55, 0, s55
    buffer_load_dwordx4 v10, s[20:23], s50 offen  lds
    s_add_u32 m0, s48, 62464
    s_nop 0
    buffer_load_dwordx4 v11, s[20:23], s50 offen  lds
    s_add_u32 m0, s48, 63488
    s_nop 0
    buffer_load_dwordx4 v12, s[20:23], s50 offen  lds
    s_add_u32 m0, s48, 64512
    s_nop 0
    buffer_load_dwordx4 v13, s[20:23], s50 offen  lds
    s_add_u32 m0, s48, 65536
    s_nop 0
    buffer_load_dwordx4 v14, s[20:23], s50 offen  lds
    s_add_u32 m0, s48, 66560
    s_nop 0
    buffer_load_dwordx4 v15, s[20:23], s50 offen  lds
    s_add_u32 m0, s48, 67584
    s_nop 0
    buffer_load_dwordx4 v16, s[20:23], s50 offen  lds
    s_add_u32 m0, s48, 68608
    s_nop 0
    buffer_load_dwordx4 v17, s[20:23], s50 offen  lds
    s_add_u32 m0, s48, 69632
    s_nop 0
    buffer_load_dwordx4 v18, s[20:23], s50 offen  lds
    s_waitcnt vmcnt(9) lgkmcnt(0)
    s_barrier
    ds_read_b32 v56, v34 offset:32768
    s_mul_i32 s50, s55, s40
    s_add_u32 s50, s50, s41
    s_add_u32 m0, s48, 0
    s_add_u32 s55, s55, 1
    s_cmp_eq_u32 s55, 9
    s_cselect_b32 s55, 0, s55
    buffer_load_dwordx4 v10, s[20:23], s50 offen  lds
    s_add_u32 m0, s48, 1024
    s_nop 0
    buffer_load_dwordx4 v11, s[20:23], s50 offen  lds
    s_add_u32 m0, s48, 2048
    s_nop 0
    buffer_load_dwordx4 v12, s[20:23], s50 offen  lds
    s_add_u32 m0, s48, 3072
    s_nop 0
    buffer_load_dwordx4 v13, s[20:23], s50 offen  lds
    s_add_u32 m0, s48, 4096
    s_nop 0
    buffer_load_dwordx4 v14, s[20:23], s50 offen  lds
    s_add_u32 m0, s48, 5120
    s_nop 0
    buffer_load_dwordx4 v15, s[20:23], s50 offen  lds
    s_add_u32 m0, s48, 6144
    s_nop 0
    buffer_load_dwordx4 v16, s[20:23], s50 offen  lds
    s_add_u32 m0, s48, 7168
    s_nop 0
    buffer_load_dwordx4 v17, s[20:23], s50 offen  lds
    s_add_u32 m0, s48, 8192
    s_nop 0
    buffer_load_dwordx4 v18, s[20:23], s50 offen  lds
    s_waitcnt vmcnt(9) lgkmcnt(0)
    s_barrier
    ds_read_b32 v57, v34 offset:49152
    s_waitcnt vmcnt(0) lgkmcnt(0)
    s_barrier
    ds_read_b32 v58, v34 offset:0
    s_branch L1_gate
L1_xloader:
    s_lshl_b32 s44, s32, 7
    s_lshl_b32 s45, s37, 6
    s_add_u32 s44, s44, s45
    s_movk_i32 s46, 1152
    v_lshrrev_b32 v4, 3, v1
    v_add_u32 v4, s44, v4
    v_mul_lo_u32 v4, v4, s46
    v_lshrrev_b32 v5, 4, v1
    v_xor_b32 v5, v5, v1
    v_and_b32 v5, 7, v5
    v_lshl_add_u32 v10, v5, 4, v4
    v_xor_b32 v5, 4, v5
    v_lshl_add_u32 v11, v5, 4, v4
    v_lshrrev_b32 v4, 1, v1
    v_mul_u32_u24 v4, 36, v4
    v_and_b32 v5, 1, v1
    v_lshl_add_u32 v12, v5, 4, v4
    s_and_b32 s45, s33, 1
    s_lshl_b32 s45, s45, 2
    s_mul_i32 s41, s37, 1152
    s_add_u32 s41, s41, s45
    s_sub_u32 s44, s34, 1
    s_and_b32 s45, s33, 2
    s_or_b32 s44, s44, s45
    s_cmp_lt_u32 s44, 2
    s_cselect_b32 s41, s41, 0x7ff00000
    v_add_u32 v12, s41, v12
    s_lshl_b32 s48, s37, 13
    s_lshl_b32 s49, s37, 10
    s_waitcnt lgkmcnt(0)

    s_mov_b32 s20, s4
    s_mov_b32 s21, s5
    s_mov_b32 s22, 2359296
    s_mov_b32 s23, 0x00020000
    s_cmp_eq_u32 s34, 2
    s_cselect_b32 s60, s12, s10
    s_cselect_b32 s61, s13, s11
    s_mov_b32 s62, 20736
    s_mov_b32 s63, 0x00020000

    s_lshl_b32 s50, s55, 7
    s_mul_i32 s51, s55, 2304
    s_add_u32 m0, s48, 81920
    s_add_u32 s55, s55, 1
    s_cmp_eq_u32 s55, 9
    s_cselect_b32 s55, 0, s55
    buffer_load_dwordx4 v10, s[20:23], s50 offen  lds
    s_add_u32 m0, s48, 82944
    s_add_u32 s50, s50, 9216
    buffer_load_dwordx4 v11, s[20:23], s50 offen  lds
    s_add_u32 m0, s48, 83968
    s_add_u32 s50, s50, 9216
    buffer_load_dwordx4 v10, s[20:23], s50 offen  lds
    s_add_u32 m0, s48, 84992
    s_add_u32 s50, s50, 9216
    buffer_load_dwordx4 v11, s[20:23], s50 offen  lds
    s_add_u32 m0, s48, 86016
    s_add_u32 s50, s50, 9216
    buffer_load_dwordx4 v10, s[20:23], s50 offen  lds
    s_add_u32 m0, s48, 87040
    s_add_u32 s50, s50, 9216
    buffer_load_dwordx4 v11, s[20:23], s50 offen  lds
    s_add_u32 m0, s48, 88064
    s_add_u32 s50, s50, 9216
    buffer_load_dwordx4 v10, s[20:23], s50 offen  lds
    s_add_u32 m0, s48, 89088
    s_add_u32 s50, s50, 9216
    buffer_load_dwordx4 v11, s[20:23], s50 offen  lds
    s_add_u32 m0, s49, 18432
    s_nop 0
    buffer_load_dwordx4 v12, s[60:63], s51 offen lds
    s_lshl_b32 s50, s55, 7
    s_mul_i32 s51, s55, 2304
    s_add_u32 m0, s48, 98304
    s_add_u32 s55, s55, 1
    s_cmp_eq_u32 s55, 9
    s_cselect_b32 s55, 0, s55
    buffer_load_dwordx4 v10, s[20:23], s50 offen  lds
    s_add_u32 m0, s48, 99328
    s_add_u32 s50, s50, 9216
    buffer_load_dwordx4 v11, s[20:23], s50 offen  lds
    s_add_u32 m0, s48, 100352
    s_add_u32 s50, s50, 9216
    buffer_load_dwordx4 v10, s[20:23], s50 offen  lds
    s_add_u32 m0, s48, 101376
    s_add_u32 s50, s50, 9216
    buffer_load_dwordx4 v11, s[20:23], s50 offen  lds
    s_add_u32 m0, s48, 102400
    s_add_u32 s50, s50, 9216
    buffer_load_dwordx4 v10, s[20:23], s50 offen  lds
    s_add_u32 m0, s48, 103424
    s_add_u32 s50, s50, 9216
    buffer_load_dwordx4 v11, s[20:23], s50 offen  lds
    s_add_u32 m0, s48, 104448
    s_add_u32 s50, s50, 9216
    buffer_load_dwordx4 v10, s[20:23], s50 offen  lds
    s_add_u32 m0, s48, 105472
    s_add_u32 s50, s50, 9216
    buffer_load_dwordx4 v11, s[20:23], s50 offen  lds
    s_add_u32 m0, s49, 38912
    s_nop 0
    buffer_load_dwordx4 v12, s[60:63], s51 offen lds
    s_mov_b32 s28, s14
    s_mov_b32 s29, s15
    s_mov_b32 s30, 1152
    s_mov_b32 s31, 0x00020000
    s_mov_b32 s24, s16
    s_mov_b32 s25, s17
    s_mov_b32 s26, 15974528
    s_mov_b32 s27, 0x00020000
    v_and_b32 v2, 31, v1
    v_lshlrev_b32 v3, 2, v2
    s_lshl_b32 s50, s56, 7
    s_add_u32 s56, s56, 1
    s_cmp_eq_u32 s56, 9
    s_cselect_b32 s56, 0, s56
    buffer_load_dword v40, v3, s[28:31], s50 offen
    s_lshl_b32 s50, s56, 7
    s_add_u32 s56, s56, 1
    s_cmp_eq_u32 s56, 9
    s_cselect_b32 s56, 0, s56
    buffer_load_dword v41, v3, s[28:31], s50 offen
    s_lshl_b32 s50, s56, 7
    s_add_u32 s56, s56, 1
    s_cmp_eq_u32 s56, 9
    s_cselect_b32 s56, 0, s56
    buffer_load_dword v42, v3, s[28:31], s50 offen
    s_lshl_b32 s50, s56, 7
    s_add_u32 s56, s56, 1
    s_cmp_eq_u32 s56, 9
    s_cselect_b32 s56, 0, s56
    buffer_load_dword v43, v3, s[28:31], s50 offen
    s_lshl_b32 s50, s56, 7
    s_add_u32 s56, s56, 1
    s_cmp_eq_u32 s56, 9
    s_cselect_b32 s56, 0, s56
    buffer_load_dword v44, v3, s[28:31], s50 offen
    s_lshl_b32 s50, s56, 7
    s_add_u32 s56, s56, 1
    s_cmp_eq_u32 s56, 9
    s_cselect_b32 s56, 0, s56
    buffer_load_dword v45, v3, s[28:31], s50 offen
    s_lshl_b32 s50, s56, 7
    s_add_u32 s56, s56, 1
    s_cmp_eq_u32 s56, 9
    s_cselect_b32 s56, 0, s56
    buffer_load_dword v46, v3, s[28:31], s50 offen
    s_lshl_b32 s50, s56, 7
    s_add_u32 s56, s56, 1
    s_cmp_eq_u32 s56, 9
    s_cselect_b32 s56, 0, s56
    buffer_load_dword v47, v3, s[28:31], s50 offen
    s_lshl_b32 s50, s56, 7
    s_add_u32 s56, s56, 1
    s_cmp_eq_u32 s56, 9
    s_cselect_b32 s56, 0, s56
    buffer_load_dword v48, v3, s[28:31], s50 offen
    s_lshl_b32 s44, s33, 3
    s_lshl_b32 s45, s36, 1
    s_add_u32 s44, s44, s45
    v_lshrrev_b32 v4, 5, v1
    v_add_u32 v35, s44, v4
    v_lshrrev_b32 v5, 1, v35
    v_lshrrev_b32 v6, 2, v2
    v_xor_b32 v5, v5, v6
    v_and_b32 v5, 7, v5
    v_lshlrev_b32 v5, 4, v5
    v_and_b32 v6, 3, v1
    v_lshl_add_u32 v5, v6, 2, v5
    v_lshl_add_u32 v34, v35, 7, v5
    v_add_u32 v34, 81920, v34

    s_waitcnt vmcnt(18) lgkmcnt(0)
    s_barrier
    ds_read_b32 v50, v34 offset:0
    s_lshl_b32 s50, s55, 7
    s_mul_i32 s51, s55, 2304
    s_add_u32 m0, s48, 114688
    s_add_u32 s55, s55, 1
    s_cmp_eq_u32 s55, 9
    s_cselect_b32 s55, 0, s55
    buffer_load_dwordx4 v10, s[20:23], s50 offen  lds
    s_add_u32 m0, s48, 115712
    s_add_u32 s50, s50, 9216
    buffer_load_dwordx4 v11, s[20:23], s50 offen  lds
    s_add_u32 m0, s48, 116736
    s_add_u32 s50, s50, 9216
    buffer_load_dwordx4 v10, s[20:23], s50 offen  lds
    s_add_u32 m0, s48, 117760
    s_add_u32 s50, s50, 9216
    buffer_load_dwordx4 v11, s[20:23], s50 offen  lds
    s_add_u32 m0, s48, 118784
    s_add_u32 s50, s50, 9216
    buffer_load_dwordx4 v10, s[20:23], s50 offen  lds
    s_add_u32 m0, s48, 119808
    s_add_u32 s50, s50, 9216
    buffer_load_dwordx4 v11, s[20:23], s50 offen  lds
    s_add_u32 m0, s48, 120832
    s_add_u32 s50, s50, 9216
    buffer_load_dwordx4 v10, s[20:23], s50 offen  lds
    s_add_u32 m0, s48, 121856
    s_add_u32 s50, s50, 9216
    buffer_load_dwordx4 v11, s[20:23], s50 offen  lds
    s_add_u32 m0, s49, 59392
    s_nop 0
    buffer_load_dwordx4 v12, s[60:63], s51 offen lds
    s_waitcnt vmcnt(18) lgkmcnt(0)
    s_barrier
    ds_read_b32 v51, v34 offset:16384
    s_lshl_b32 s50, s55, 7
    s_mul_i32 s51, s55, 2304
    s_add_u32 m0, s48, 131072
    s_add_u32 s55, s55, 1
    s_cmp_eq_u32 s55, 9
    s_cselect_b32 s55, 0, s55
    buffer_load_dwordx4 v10, s[20:23], s50 offen  lds
    s_add_u32 m0, s48, 132096
    s_add_u32 s50, s50, 9216
    buffer_load_dwordx4 v11, s[20:23], s50 offen  lds
    s_add_u32 m0, s48, 133120
    s_add_u32 s50, s50, 9216
    buffer_load_dwordx4 v10, s[20:23], s50 offen  lds
    s_add_u32 m0, s48, 134144
    s_add_u32 s50, s50, 9216
    buffer_load_dwordx4 v11, s[20:23], s50 offen  lds
    s_add_u32 m0, s48, 135168
    s_add_u32 s50, s50, 9216
    buffer_load_dwordx4 v10, s[20:23], s50 offen  lds
    s_add_u32 m0, s48, 136192
    s_add_u32 s50, s50, 9216
    buffer_load_dwordx4 v11, s[20:23], s50 offen  lds
    s_add_u32 m0, s48, 137216
    s_add_u32 s50, s50, 9216
    buffer_load_dwordx4 v10, s[20:23], s50 offen  lds
    s_add_u32 m0, s48, 138240
    s_add_u32 s50, s50, 9216
    buffer_load_dwordx4 v11, s[20:23], s50 offen  lds
    s_add_u32 m0, s49, 79872
    s_nop 0
    buffer_load_dwordx4 v12, s[60:63], s51 offen lds
    s_waitcnt vmcnt(9) lgkmcnt(0)
    s_barrier
    ds_read_b32 v52, v34 offset:32768
    s_lshl_b32 s50, s55, 7
    s_mul_i32 s51, s55, 2304
    s_add_u32 m0, s48, 81920
    s_add_u32 s55, s55, 1
    s_cmp_eq_u32 s55, 9
    s_cselect_b32 s55, 0, s55
    buffer_load_dwordx4 v10, s[20:23], s50 offen  lds
    s_add_u32 m0, s48, 82944
    s_add_u32 s50, s50, 9216
    buffer_load_dwordx4 v11, s[20:23], s50 offen  lds
    s_add_u32 m0, s48, 83968
    s_add_u32 s50, s50, 9216
    buffer_load_dwordx4 v10, s[20:23], s50 offen  lds
    s_add_u32 m0, s48, 84992
    s_add_u32 s50, s50, 9216
    buffer_load_dwordx4 v11, s[20:23], s50 offen  lds
    s_add_u32 m0, s48, 86016
    s_add_u32 s50, s50, 9216
    buffer_load_dwordx4 v10, s[20:23], s50 offen  lds
    s_add_u32 m0, s48, 87040
    s_add_u32 s50, s50, 9216
    buffer_load_dwordx4 v11, s[20:23], s50 offen  lds
    s_add_u32 m0, s48, 88064
    s_add_u32 s50, s50, 9216
    buffer_load_dwordx4 v10, s[20:23], s50 offen  lds
    s_add_u32 m0, s48, 89088
    s_add_u32 s50, s50, 9216
    buffer_load_dwordx4 v11, s[20:23], s50 offen  lds
    s_add_u32 m0, s49, 18432
    s_nop 0
    buffer_load_dwordx4 v12, s[60:63], s51 offen lds
    s_waitcnt vmcnt(9) lgkmcnt(0)
    s_barrier
    ds_read_b32 v53, v34 offset:49152
    s_lshl_b32 s50, s55, 7
    s_mul_i32 s51, s55, 2304
    s_add_u32 m0, s48, 98304
    s_add_u32 s55, s55, 1
    s_cmp_eq_u32 s55, 9
    s_cselect_b32 s55, 0, s55
    buffer_load_dwordx4 v10, s[20:23], s50 offen  lds
    s_add_u32 m0, s48, 99328
    s_add_u32 s50, s50, 9216
    buffer_load_dwordx4 v11, s[20:23], s50 offen  lds
    s_add_u32 m0, s48, 100352
    s_add_u32 s50, s50, 9216
    buffer_load_dwordx4 v10, s[20:23], s50 offen  lds
    s_add_u32 m0, s48, 101376
    s_add_u32 s50, s50, 9216
    buffer_load_dwordx4 v11, s[20:23], s50 offen  lds
    s_add_u32 m0, s48, 102400
    s_add_u32 s50, s50, 9216
    buffer_load_dwordx4 v10, s[20:23], s50 offen  lds
    s_add_u32 m0, s48, 103424
    s_add_u32 s50, s50, 9216
    buffer_load_dwordx4 v11, s[20:23], s50 offen  lds
    s_add_u32 m0, s48, 104448
    s_add_u32 s50, s50, 9216
    buffer_load_dwordx4 v10, s[20:23], s50 offen  lds
    s_add_u32 m0, s48, 105472
    s_add_u32 s50, s50, 9216
    buffer_load_dwordx4 v11, s[20:23], s50 offen  lds
    s_add_u32 m0, s49, 38912
    s_nop 0
    buffer_load_dwordx4 v12, s[60:63], s51 offen lds
    s_waitcnt vmcnt(9) lgkmcnt(0)
    s_barrier
    ds_read_b32 v54, v34 offset:0
    s_lshl_b32 s50, s55, 7
    s_mul_i32 s51, s55, 2304
    s_add_u32 m0, s48, 114688
    s_add_u32 s55, s55, 1
    s_cmp_eq_u32 s55, 9
    s_cselect_b32 s55, 0, s55
    buffer_load_dwordx4 v10, s[20:23], s50 offen  lds
    s_add_u32 m0, s48, 115712
    s_add_u32 s50, s50, 9216
    buffer_load_dwordx4 v11, s[20:23], s50 offen  lds
    s_add_u32 m0, s48, 116736
    s_add_u32 s50, s50, 9216
    buffer_load_dwordx4 v10, s[20:23], s50 offen  lds
    s_add_u32 m0, s48, 117760
    s_add_u32 s50, s50, 9216
    buffer_load_dwordx4 v11, s[20:23], s50 offen  lds
    s_add_u32 m0, s48, 118784
    s_add_u32 s50, s50, 9216
    buffer_load_dwordx4 v10, s[20:23], s50 offen  lds
    s_add_u32 m0, s48, 119808
    s_add_u32 s50, s50, 9216
    buffer_load_dwordx4 v11, s[20:23], s50 offen  lds
    s_add_u32 m0, s48, 120832
    s_add_u32 s50, s50, 9216
    buffer_load_dwordx4 v10, s[20:23], s50 offen  lds
    s_add_u32 m0, s48, 121856
    s_add_u32 s50, s50, 9216
    buffer_load_dwordx4 v11, s[20:23], s50 offen  lds
    s_add_u32 m0, s49, 59392
    s_nop 0
    buffer_load_dwordx4 v12, s[60:63], s51 offen lds
    s_waitcnt vmcnt(9) lgkmcnt(0)
    s_barrier
    ds_read_b32 v55, v34 offset:16384
    s_lshl_b32 s50, s55, 7
    s_mul_i32 s51, s55, 2304
    s_add_u32 m0, s48, 131072
    s_add_u32 s55, s55, 1
    s_cmp_eq_u32 s55, 9
    s_cselect_b32 s55, 0, s55
    buffer_load_dwordx4 v10, s[20:23], s50 offen  lds
    s_add_u32 m0, s48, 132096
    s_add_u32 s50, s50, 9216
    buffer_load_dwordx4 v11, s[20:23], s50 offen  lds
    s_add_u32 m0, s48, 133120
    s_add_u32 s50, s50, 9216
    buffer_load_dwordx4 v10, s[20:23], s50 offen  lds
    s_add_u32 m0, s48, 134144
    s_add_u32 s50, s50, 9216
    buffer_load_dwordx4 v11, s[20:23], s50 offen  lds
    s_add_u32 m0, s48, 135168
    s_add_u32 s50, s50, 9216
    buffer_load_dwordx4 v10, s[20:23], s50 offen  lds
    s_add_u32 m0, s48, 136192
    s_add_u32 s50, s50, 9216
    buffer_load_dwordx4 v11, s[20:23], s50 offen  lds
    s_add_u32 m0, s48, 137216
    s_add_u32 s50, s50, 9216
    buffer_load_dwordx4 v10, s[20:23], s50 offen  lds
    s_add_u32 m0, s48, 138240
    s_add_u32 s50, s50, 9216
    buffer_load_dwordx4 v11, s[20:23], s50 offen  lds
    s_add_u32 m0, s49, 79872
    s_nop 0
    buffer_load_dwordx4 v12, s[60:63], s51 offen lds
    s_waitcnt vmcnt(9) lgkmcnt(0)
    s_barrier
    ds_read_b32 v56, v34 offset:32768
    s_lshl_b32 s50, s55, 7
    s_mul_i32 s51, s55, 2304
    s_add_u32 m0, s48, 81920
    s_add_u32 s55, s55, 1
    s_cmp_eq_u32 s55, 9
    s_cselect_b32 s55, 0, s55
    buffer_load_dwordx4 v10, s[20:23], s50 offen  lds
    s_add_u32 m0, s48, 82944
    s_add_u32 s50, s50, 9216
    buffer_load_dwordx4 v11, s[20:23], s50 offen  lds
    s_add_u32 m0, s48, 83968
    s_add_u32 s50, s50, 9216
    buffer_load_dwordx4 v10, s[20:23], s50 offen  lds
    s_add_u32 m0, s48, 84992
    s_add_u32 s50, s50, 9216
    buffer_load_dwordx4 v11, s[20:23], s50 offen  lds
    s_add_u32 m0, s48, 86016
    s_add_u32 s50, s50, 9216
    buffer_load_dwordx4 v10, s[20:23], s50 offen  lds
    s_add_u32 m0, s48, 87040
    s_add_u32 s50, s50, 9216
    buffer_load_dwordx4 v11, s[20:23], s50 offen  lds
    s_add_u32 m0, s48, 88064
    s_add_u32 s50, s50, 9216
    buffer_load_dwordx4 v10, s[20:23], s50 offen  lds
    s_add_u32 m0, s48, 89088
    s_add_u32 s50, s50, 9216
    buffer_load_dwordx4 v11, s[20:23], s50 offen  lds
    s_add_u32 m0, s49, 18432
    s_nop 0
    buffer_load_dwordx4 v12, s[60:63], s51 offen lds
    s_waitcnt vmcnt(9) lgkmcnt(0)
    s_barrier
    ds_read_b32 v57, v34 offset:49152
    s_waitcnt vmcnt(0) lgkmcnt(0)
    s_barrier
    ds_read_b32 v58, v34 offset:0
    s_nop 0
L1_gate:
    s_mov_b32 s51, 0xffff0000
    v_mov_b32 v36, 0
    s_waitcnt lgkmcnt(0)
    v_lshlrev_b32 v4, 16, v50
    v_and_b32 v5, s51, v50
    v_lshlrev_b32 v6, 16, v40
    v_and_b32 v7, s51, v40
    v_mul_f32 v4, v4, v6
    v_mul_f32 v5, v5, v7
    v_cvt_pk_bf16_f32 v4, v4, v5
    v_lshlrev_b32 v5, 16, v4
    v_and_b32 v4, s51, v4
    v_add_f32 v36, v36, v5
    v_add_f32 v36, v36, v4

    v_lshlrev_b32 v4, 16, v51
    v_and_b32 v5, s51, v51
    v_lshlrev_b32 v6, 16, v41
    v_and_b32 v7, s51, v41
    v_mul_f32 v4, v4, v6
    v_mul_f32 v5, v5, v7
    v_cvt_pk_bf16_f32 v4, v4, v5
    v_lshlrev_b32 v5, 16, v4
    v_and_b32 v4, s51, v4
    v_add_f32 v36, v36, v5
    v_add_f32 v36, v36, v4

    v_lshlrev_b32 v4, 16, v52
    v_and_b32 v5, s51, v52
    v_lshlrev_b32 v6, 16, v42
    v_and_b32 v7, s51, v42
    v_mul_f32 v4, v4, v6
    v_mul_f32 v5, v5, v7
    v_cvt_pk_bf16_f32 v4, v4, v5
    v_lshlrev_b32 v5, 16, v4
    v_and_b32 v4, s51, v4
    v_add_f32 v36, v36, v5
    v_add_f32 v36, v36, v4

    v_lshlrev_b32 v4, 16, v53
    v_and_b32 v5, s51, v53
    v_lshlrev_b32 v6, 16, v43
    v_and_b32 v7, s51, v43
    v_mul_f32 v4, v4, v6
    v_mul_f32 v5, v5, v7
    v_cvt_pk_bf16_f32 v4, v4, v5
    v_lshlrev_b32 v5, 16, v4
    v_and_b32 v4, s51, v4
    v_add_f32 v36, v36, v5
    v_add_f32 v36, v36, v4

    v_lshlrev_b32 v4, 16, v54
    v_and_b32 v5, s51, v54
    v_lshlrev_b32 v6, 16, v44
    v_and_b32 v7, s51, v44
    v_mul_f32 v4, v4, v6
    v_mul_f32 v5, v5, v7
    v_cvt_pk_bf16_f32 v4, v4, v5
    v_lshlrev_b32 v5, 16, v4
    v_and_b32 v4, s51, v4
    v_add_f32 v36, v36, v5
    v_add_f32 v36, v36, v4

    v_lshlrev_b32 v4, 16, v55
    v_and_b32 v5, s51, v55
    v_lshlrev_b32 v6, 16, v45
    v_and_b32 v7, s51, v45
    v_mul_f32 v4, v4, v6
    v_mul_f32 v5, v5, v7
    v_cvt_pk_bf16_f32 v4, v4, v5
    v_lshlrev_b32 v5, 16, v4
    v_and_b32 v4, s51, v4
    v_add_f32 v36, v36, v5
    v_add_f32 v36, v36, v4

    v_lshlrev_b32 v4, 16, v56
    v_and_b32 v5, s51, v56
    v_lshlrev_b32 v6, 16, v46
    v_and_b32 v7, s51, v46
    v_mul_f32 v4, v4, v6
    v_mul_f32 v5, v5, v7
    v_cvt_pk_bf16_f32 v4, v4, v5
    v_lshlrev_b32 v5, 16, v4
    v_and_b32 v4, s51, v4
    v_add_f32 v36, v36, v5
    v_add_f32 v36, v36, v4

    v_lshlrev_b32 v4, 16, v57
    v_and_b32 v5, s51, v57
    v_lshlrev_b32 v6, 16, v47
    v_and_b32 v7, s51, v47
    v_mul_f32 v4, v4, v6
    v_mul_f32 v5, v5, v7
    v_cvt_pk_bf16_f32 v4, v4, v5
    v_lshlrev_b32 v5, 16, v4
    v_and_b32 v4, s51, v4
    v_add_f32 v36, v36, v5
    v_add_f32 v36, v36, v4

    v_lshlrev_b32 v4, 16, v58
    v_and_b32 v5, s51, v58
    v_lshlrev_b32 v6, 16, v48
    v_and_b32 v7, s51, v48
    v_mul_f32 v4, v4, v6
    v_mul_f32 v5, v5, v7
    v_cvt_pk_bf16_f32 v4, v4, v5
    v_lshlrev_b32 v5, 16, v4
    v_and_b32 v4, s51, v4
    v_add_f32 v36, v36, v5
    v_add_f32 v36, v36, v4

    ds_swizzle_b32 v4, v36 offset:0x41f
    s_waitcnt lgkmcnt(0)
    v_add_f32 v36, v36, v4
    ds_swizzle_b32 v4, v36 offset:0x81f
    s_waitcnt lgkmcnt(0)
    v_add_f32 v36, v36, v4
    ds_swizzle_b32 v4, v36 offset:0x101f
    s_waitcnt lgkmcnt(0)
    v_add_f32 v36, v36, v4
    ds_swizzle_b32 v4, v36 offset:0x201f
    s_waitcnt lgkmcnt(0)
    v_add_f32 v36, v36, v4
    ds_swizzle_b32 v4, v36 offset:0x401f
    s_waitcnt lgkmcnt(0)
    v_add_f32 v36, v36, v4
    v_cvt_pk_bf16_f32 v4, v36, v36
    v_lshlrev_b32 v4, 16, v4
    v_mul_f32 v4, 0xbfb8aa3b, v4
    v_exp_f32 v4, v4
    s_nop 0
    v_add_f32 v4, 1.0, v4
    v_rcp_f32 v4, v4
    s_nop 0
    v_cvt_pk_bf16_f32 v4, v4, v4
    v_lshlrev_b32 v4, 16, v4
    v_sub_f32 v5, 1.0, v4
    v_cvt_pk_bf16_f32 v5, v5, v5
    v_lshlrev_b32 v5, 16, v5
    s_lshl_b32 s44, s32, 7
    v_add_u32 v6, s44, v35
    v_lshlrev_b32 v6, 3, v6
    v_cmp_eq_u32 vcc, 0, v2
    v_mov_b32 v7, 0x7ff00000
    s_mov_b32 s44, 15794176
    v_cndmask_b32 v6, v7, v6, vcc
    buffer_store_dwordx2 v[4:5], v6, s[24:27], s44 offen

    s_endpgm
L1_consumer:
    v_and_b32 v2, 31, v1
    v_lshrrev_b32 v3, 5, v1
    s_and_b32 s36, s35, 1
    s_lshr_b32 s37, s35, 1
    s_lshl_b32 s38, s36, 1
    s_add_u32 s38, s38, s37
    s_xor_b32 s39, s38, 1
    v_bfe_u32 v40, v1, 2, 2
    v_lshlrev_b32 v41, 2, v3
    v_add_u32 v41, v41, v40
    v_mul_u32_u24 v42, 576, v41
    v_lshl_add_u32 v43, v3, 3, v40
    v_lshlrev_b32 v43, 5, v43
    v_lshrrev_b32 v44, 2, v1
    v_and_b32 v44, 4, v44
    v_and_b32 v45, 3, v1
    v_or_b32 v44, v44, v45
    s_lshl_b32 s44, s32, 2
    s_add_u32 s52, s44, s38
    s_lshr_b32 s53, s52, 3
    s_mul_i32 s53, s53, 9216
    s_and_b32 s54, s52, 7
    s_xor_b32 s57, s54, 1

    s_waitcnt lgkmcnt(0)
    s_mov_b32 s24, s16
    s_mov_b32 s25, s17
    s_mov_b32 s26, 15974528
    s_mov_b32 s27, 0x00020000
    s_lshl_b32 s40, s2, 2
    s_add_u32 s40, s40, s35
    s_mov_b32 s30, 663552
    s_mov_b32 s31, 0x00020000
    s_mov_b32 s41, 164736
    v_lshlrev_b32 v45, 1, v1

    s_lshl_b32 s44, s40, 4
    s_add_u32 s44, s44, 15941632
    v_lshlrev_b32 v46, 2, v1
    v_mov_b32 v47, 0x7ff00000
    v_cmp_gt_u32 vcc, 4, v1
    v_mov_b32 v48, 0
    s_nop 0
    v_cndmask_b32 v46, v47, v46, vcc
    buffer_store_dword v48, v46, s[24:27], s44 offen

    s_cmp_eq_u32 s34, 2
    s_cbranch_scc1 L1_vtype
    v_lshrrev_b32 v46, 1, v2
    v_and_b32 v46, 7, v46
    v_xor_b32 v46, v46, v3
    s_lshl_b32 s44, s38, 12
    s_add_u32 s44, s44, 81920
    v_lshlrev_b32 v47, 7, v2
    v_add_u32 v47, s44, v47

    v_xor_b32 v4, 0, v46
    v_lshl_add_u32 v4, v4, 4, v47
    v_xor_b32 v8, 0x1000, v4
    v_xor_b32 v5, 2, v46
    v_lshl_add_u32 v5, v5, 4, v47
    v_xor_b32 v9, 0x1000, v5
    v_xor_b32 v6, 4, v46
    v_lshl_add_u32 v6, v6, 4, v47
    v_xor_b32 v10, 0x1000, v6
    v_xor_b32 v7, 6, v46
    v_lshl_add_u32 v7, v7, 4, v47
    v_xor_b32 v11, 0x1000, v7
    v_lshrrev_b32 v46, 2, v44
    v_mul_u32_u24 v46, 40, v46
    v_and_b32 v47, 1, v44
    v_lshlrev_b32 v47, 4, v47
    v_and_b32 v48, 2, v44
    v_lshl_add_u32 v47, v48, 2, v47
    s_mul_i32 s44, s37, 144
    v_add3_u32 v12, v42, v46, v47
    v_add_u32 v12, s44, v12
    v_add_u32 v13, 40960, v12
    v_mul_u32_u24 v48, 72, v44
    v_add3_u32 v48, v48, v42, 32
    v_add_u32 v49, v47, v43
    v_add_u32 v49, 18432, v49

    v_cmp_gt_u32 vcc, 4, v44
    v_add_u32 v46, 0, v48
    v_add_u32 v47, 0, v49
    v_cndmask_b32 v16, v47, v46, vcc
    v_add_u32 v24, 40960, v16
    v_add_u32 v46, 288, v48
    v_add_u32 v47, 128, v49
    v_cndmask_b32 v17, v47, v46, vcc
    v_add_u32 v25, 40960, v17
    v_add_u32 v46, 4608, v48
    v_add_u32 v47, 512, v49
    v_cndmask_b32 v18, v47, v46, vcc
    v_add_u32 v26, 40960, v18
    v_add_u32 v46, 4896, v48
    v_add_u32 v47, 640, v49
    v_cndmask_b32 v19, v47, v46, vcc
    v_add_u32 v27, 40960, v19
    v_add_u32 v46, 9216, v48
    v_add_u32 v47, 1024, v49
    v_cndmask_b32 v20, v47, v46, vcc
    v_add_u32 v28, 40960, v20
    v_add_u32 v46, 9504, v48
    v_add_u32 v47, 1152, v49
    v_cndmask_b32 v21, v47, v46, vcc
    v_add_u32 v29, 40960, v21
    v_add_u32 v46, 13824, v48
    v_add_u32 v47, 1536, v49
    v_cndmask_b32 v22, v47, v46, vcc
    v_add_u32 v30, 40960, v22
    v_add_u32 v46, 14112, v48
    v_add_u32 v47, 1664, v49
    v_cndmask_b32 v23, v47, v46, vcc
    v_add_u32 v31, 40960, v23
    s_cmp_eq_u32 s34, 1
    s_cselect_b32 s46, 1.0, 0x3eae1a93
    s_cselect_b32 s44, 0, 2506752
    s_mov_b32 s47, s46
    s_and_b32 s45, s33, 3
    s_lshl_b32 s45, s45, 3
    s_cmp_eq_u32 s34, 3
    s_cselect_b32 s48, 32, 0
    s_add_u32 s45, s45, s48
    s_mul_i32 s45, s45, 73728
    s_add_u32 s44, s44, s45
    s_add_u32 s44, s44, s53
    s_lshl_b32 s45, s54, 7
    s_add_u32 s49, s44, s45
    s_add_u32 s49, s49, 8192
    s_mul_i32 s45, s37, 294912
    s_add_u32 s44, s44, s45
    s_lshl_b32 s45, s54, 10
    s_add_u32 s58, s44, s45
    s_lshl_b32 s45, s57, 10
    s_add_u32 s59, s44, s45
    v_lshlrev_b32 v32, 4, v1
    v_lshlrev_b32 v34, 2, v2
    s_mov_b32 s45, 147456
    v_mul_lo_u32 v33, v3, s45
    v_add_u32 v33, v33, v34

    s_barrier
    ds_read_b128 v[40:43], v4 offset:0
    ds_read_b64_tr_b16 v[48:49], v12 offset:0
    ds_read_b64_tr_b16 v[50:51], v12 offset:288
    ds_read_b128 v[44:47], v8 offset:0
    ds_read_b64_tr_b16 v[52:53], v12 offset:72
    ds_read_b64_tr_b16 v[54:55], v12 offset:360
    ds_read_b64_tr_b16 v[56:57], v16 offset:0
    ds_read_b64_tr_b16 v[58:59], v17 offset:0
    ds_read_b128 v[60:63], v5 offset:0
    ds_read_b64_tr_b16 v[68:69], v12 offset:4608
    ds_read_b64_tr_b16 v[70:71], v12 offset:4896
    ds_read_b128 v[64:67], v9 offset:0
    ds_read_b64_tr_b16 v[72:73], v12 offset:4680
    ds_read_b64_tr_b16 v[74:75], v12 offset:4968
    ds_read_b64_tr_b16 v[76:77], v18 offset:0
    s_waitcnt lgkmcnt(7)
    ds_read_b64_tr_b16 v[78:79], v19 offset:0
    v_mfma_f32_32x32x16_bf16 v[80:95], v[48:51], v[40:43], 0
    ds_read_b128 v[160:163], v6 offset:0
    ds_read_b64_tr_b16 v[168:169], v12 offset:9216
    v_mfma_f32_32x32x16_bf16 v[96:111], v[48:51], v[44:47], 0
    ds_read_b64_tr_b16 v[170:171], v12 offset:9504
    ds_read_b128 v[164:167], v10 offset:0
    v_mfma_f32_32x32x16_bf16 v[112:127], v[52:55], v[40:43], 0
    ds_read_b64_tr_b16 v[172:173], v12 offset:9288
    ds_read_b64_tr_b16 v[174:175], v12 offset:9576
    v_mfma_f32_32x32x16_bf16 v[128:143], v[52:55], v[44:47], 0
    ds_read_b64_tr_b16 v[176:177], v20 offset:0
    ds_read_b64_tr_b16 v[178:179], v21 offset:0
    v_mfma_f32_32x32x16_bf16 v[144:159], v[56:59], v[40:43], 0
    s_waitcnt lgkmcnt(8)
    v_mfma_f32_32x32x16_bf16 v[80:95], v[68:71], v[60:63], v[80:95]
    ds_read_b128 v[180:183], v7 offset:0
    ds_read_b64_tr_b16 v[188:189], v12 offset:13824
    v_mfma_f32_32x32x16_bf16 v[96:111], v[68:71], v[64:67], v[96:111]
    ds_read_b64_tr_b16 v[190:191], v12 offset:14112
    ds_read_b128 v[184:187], v11 offset:0
    v_mfma_f32_32x32x16_bf16 v[112:127], v[72:75], v[60:63], v[112:127]
    ds_read_b64_tr_b16 v[192:193], v12 offset:13896
    ds_read_b64_tr_b16 v[194:195], v12 offset:14184
    v_mfma_f32_32x32x16_bf16 v[128:143], v[72:75], v[64:67], v[128:143]
    ds_read_b64_tr_b16 v[196:197], v22 offset:0
    ds_read_b64_tr_b16 v[198:199], v23 offset:0
    v_mfma_f32_32x32x16_bf16 v[144:159], v[76:79], v[60:63], v[144:159]
    s_waitcnt lgkmcnt(8)
    v_mfma_f32_32x32x16_bf16 v[80:95], v[168:171], v[160:163], v[80:95]
    s_barrier
    ds_read_b128 v[40:43], v4 offset:16384
    ds_read_b64_tr_b16 v[48:49], v12 offset:20480
    v_mfma_f32_32x32x16_bf16 v[96:111], v[168:171], v[164:167], v[96:111]
    ds_read_b64_tr_b16 v[50:51], v12 offset:20768
    ds_read_b128 v[44:47], v8 offset:16384
    v_mfma_f32_32x32x16_bf16 v[112:127], v[172:175], v[160:163], v[112:127]
    ds_read_b64_tr_b16 v[52:53], v12 offset:20552
    ds_read_b64_tr_b16 v[54:55], v12 offset:20840
    v_mfma_f32_32x32x16_bf16 v[128:143], v[172:175], v[164:167], v[128:143]
    ds_read_b64_tr_b16 v[56:57], v16 offset:20480
    ds_read_b64_tr_b16 v[58:59], v17 offset:20480
    v_mfma_f32_32x32x16_bf16 v[144:159], v[176:179], v[160:163], v[144:159]
    s_waitcnt lgkmcnt(8)
    v_mfma_f32_32x32x16_bf16 v[80:95], v[188:191], v[180:183], v[80:95]
    ds_read_b128 v[60:63], v5 offset:16384
    ds_read_b64_tr_b16 v[68:69], v12 offset:25088
    v_mfma_f32_32x32x16_bf16 v[96:111], v[188:191], v[184:187], v[96:111]
    ds_read_b64_tr_b16 v[70:71], v12 offset:25376
    ds_read_b128 v[64:67], v9 offset:16384
    v_mfma_f32_32x32x16_bf16 v[112:127], v[192:195], v[180:183], v[112:127]
    ds_read_b64_tr_b16 v[72:73], v12 offset:25160
    ds_read_b64_tr_b16 v[74:75], v12 offset:25448
    v_mfma_f32_32x32x16_bf16 v[128:143], v[192:195], v[184:187], v[128:143]
    ds_read_b64_tr_b16 v[76:77], v18 offset:20480
    ds_read_b64_tr_b16 v[78:79], v19 offset:20480
    v_mfma_f32_32x32x16_bf16 v[144:159], v[196:199], v[180:183], v[144:159]
    s_waitcnt lgkmcnt(8)
    v_mfma_f32_32x32x16_bf16 v[80:95], v[48:51], v[40:43], v[80:95]
    ds_read_b128 v[160:163], v6 offset:16384
    ds_read_b64_tr_b16 v[168:169], v12 offset:29696
    v_mfma_f32_32x32x16_bf16 v[96:111], v[48:51], v[44:47], v[96:111]
    ds_read_b64_tr_b16 v[170:171], v12 offset:29984
    ds_read_b128 v[164:167], v10 offset:16384
    v_mfma_f32_32x32x16_bf16 v[112:127], v[52:55], v[40:43], v[112:127]
    ds_read_b64_tr_b16 v[172:173], v12 offset:29768
    ds_read_b64_tr_b16 v[174:175], v12 offset:30056
    v_mfma_f32_32x32x16_bf16 v[128:143], v[52:55], v[44:47], v[128:143]
    ds_read_b64_tr_b16 v[176:177], v20 offset:20480
    ds_read_b64_tr_b16 v[178:179], v21 offset:20480
    v_mfma_f32_32x32x16_bf16 v[144:159], v[56:59], v[40:43], v[144:159]
    s_waitcnt lgkmcnt(8)
    v_mfma_f32_32x32x16_bf16 v[80:95], v[68:71], v[60:63], v[80:95]
    ds_read_b128 v[180:183], v7 offset:16384
    ds_read_b64_tr_b16 v[188:189], v12 offset:34304
    v_mfma_f32_32x32x16_bf16 v[96:111], v[68:71], v[64:67], v[96:111]
    ds_read_b64_tr_b16 v[190:191], v12 offset:34592
    ds_read_b128 v[184:187], v11 offset:16384
    v_mfma_f32_32x32x16_bf16 v[112:127], v[72:75], v[60:63], v[112:127]
    ds_read_b64_tr_b16 v[192:193], v12 offset:34376
    ds_read_b64_tr_b16 v[194:195], v12 offset:34664
    v_mfma_f32_32x32x16_bf16 v[128:143], v[72:75], v[64:67], v[128:143]
    ds_read_b64_tr_b16 v[196:197], v22 offset:20480
    ds_read_b64_tr_b16 v[198:199], v23 offset:20480
    v_mfma_f32_32x32x16_bf16 v[144:159], v[76:79], v[60:63], v[144:159]
    s_waitcnt lgkmcnt(8)
    v_mfma_f32_32x32x16_bf16 v[80:95], v[168:171], v[160:163], v[80:95]
    s_barrier
    ds_read_b128 v[40:43], v4 offset:32768
    ds_read_b64_tr_b16 v[48:49], v13 offset:0
    v_mfma_f32_32x32x16_bf16 v[96:111], v[168:171], v[164:167], v[96:111]
    ds_read_b64_tr_b16 v[50:51], v13 offset:288
    ds_read_b128 v[44:47], v8 offset:32768
    v_mfma_f32_32x32x16_bf16 v[112:127], v[172:175], v[160:163], v[112:127]
    ds_read_b64_tr_b16 v[52:53], v13 offset:72
    ds_read_b64_tr_b16 v[54:55], v13 offset:360
    v_mfma_f32_32x32x16_bf16 v[128:143], v[172:175], v[164:167], v[128:143]
    ds_read_b64_tr_b16 v[56:57], v24 offset:0
    ds_read_b64_tr_b16 v[58:59], v25 offset:0
    v_mfma_f32_32x32x16_bf16 v[144:159], v[176:179], v[160:163], v[144:159]
    s_waitcnt lgkmcnt(8)
    v_mfma_f32_32x32x16_bf16 v[80:95], v[188:191], v[180:183], v[80:95]
    ds_read_b128 v[60:63], v5 offset:32768
    ds_read_b64_tr_b16 v[68:69], v13 offset:4608
    v_mfma_f32_32x32x16_bf16 v[96:111], v[188:191], v[184:187], v[96:111]
    ds_read_b64_tr_b16 v[70:71], v13 offset:4896
    ds_read_b128 v[64:67], v9 offset:32768
    v_mfma_f32_32x32x16_bf16 v[112:127], v[192:195], v[180:183], v[112:127]
    ds_read_b64_tr_b16 v[72:73], v13 offset:4680
    ds_read_b64_tr_b16 v[74:75], v13 offset:4968
    v_mfma_f32_32x32x16_bf16 v[128:143], v[192:195], v[184:187], v[128:143]
    ds_read_b64_tr_b16 v[76:77], v26 offset:0
    ds_read_b64_tr_b16 v[78:79], v27 offset:0
    v_mfma_f32_32x32x16_bf16 v[144:159], v[196:199], v[180:183], v[144:159]
    s_waitcnt lgkmcnt(8)
    v_mfma_f32_32x32x16_bf16 v[80:95], v[48:51], v[40:43], v[80:95]
    ds_read_b128 v[160:163], v6 offset:32768
    ds_read_b64_tr_b16 v[168:169], v13 offset:9216
    v_mfma_f32_32x32x16_bf16 v[96:111], v[48:51], v[44:47], v[96:111]
    ds_read_b64_tr_b16 v[170:171], v13 offset:9504
    ds_read_b128 v[164:167], v10 offset:32768
    v_mfma_f32_32x32x16_bf16 v[112:127], v[52:55], v[40:43], v[112:127]
    ds_read_b64_tr_b16 v[172:173], v13 offset:9288
    ds_read_b64_tr_b16 v[174:175], v13 offset:9576
    v_mfma_f32_32x32x16_bf16 v[128:143], v[52:55], v[44:47], v[128:143]
    ds_read_b64_tr_b16 v[176:177], v28 offset:0
    ds_read_b64_tr_b16 v[178:179], v29 offset:0
    v_mfma_f32_32x32x16_bf16 v[144:159], v[56:59], v[40:43], v[144:159]
    s_waitcnt lgkmcnt(8)
    v_mfma_f32_32x32x16_bf16 v[80:95], v[68:71], v[60:63], v[80:95]
    ds_read_b128 v[180:183], v7 offset:32768
    ds_read_b64_tr_b16 v[188:189], v13 offset:13824
    v_mfma_f32_32x32x16_bf16 v[96:111], v[68:71], v[64:67], v[96:111]
    ds_read_b64_tr_b16 v[190:191], v13 offset:14112
    ds_read_b128 v[184:187], v11 offset:32768
    v_mfma_f32_32x32x16_bf16 v[112:127], v[72:75], v[60:63], v[112:127]
    ds_read_b64_tr_b16 v[192:193], v13 offset:13896
    ds_read_b64_tr_b16 v[194:195], v13 offset:14184
    v_mfma_f32_32x32x16_bf16 v[128:143], v[72:75], v[64:67], v[128:143]
    ds_read_b64_tr_b16 v[196:197], v30 offset:0
    ds_read_b64_tr_b16 v[198:199], v31 offset:0
    v_mfma_f32_32x32x16_bf16 v[144:159], v[76:79], v[60:63], v[144:159]
    s_waitcnt lgkmcnt(8)
    v_mfma_f32_32x32x16_bf16 v[80:95], v[168:171], v[160:163], v[80:95]
    s_barrier
    ds_read_b128 v[40:43], v4 offset:49152
    ds_read_b64_tr_b16 v[48:49], v13 offset:20480
    v_mfma_f32_32x32x16_bf16 v[96:111], v[168:171], v[164:167], v[96:111]
    ds_read_b64_tr_b16 v[50:51], v13 offset:20768
    ds_read_b128 v[44:47], v8 offset:49152
    v_mfma_f32_32x32x16_bf16 v[112:127], v[172:175], v[160:163], v[112:127]
    ds_read_b64_tr_b16 v[52:53], v13 offset:20552
    ds_read_b64_tr_b16 v[54:55], v13 offset:20840
    v_mfma_f32_32x32x16_bf16 v[128:143], v[172:175], v[164:167], v[128:143]
    ds_read_b64_tr_b16 v[56:57], v24 offset:20480
    ds_read_b64_tr_b16 v[58:59], v25 offset:20480
    v_mfma_f32_32x32x16_bf16 v[144:159], v[176:179], v[160:163], v[144:159]
    s_waitcnt lgkmcnt(8)
    v_mfma_f32_32x32x16_bf16 v[80:95], v[188:191], v[180:183], v[80:95]
    ds_read_b128 v[60:63], v5 offset:49152
    ds_read_b64_tr_b16 v[68:69], v13 offset:25088
    v_mfma_f32_32x32x16_bf16 v[96:111], v[188:191], v[184:187], v[96:111]
    ds_read_b64_tr_b16 v[70:71], v13 offset:25376
    ds_read_b128 v[64:67], v9 offset:49152
    v_mfma_f32_32x32x16_bf16 v[112:127], v[192:195], v[180:183], v[112:127]
    ds_read_b64_tr_b16 v[72:73], v13 offset:25160
    ds_read_b64_tr_b16 v[74:75], v13 offset:25448
    v_mfma_f32_32x32x16_bf16 v[128:143], v[192:195], v[184:187], v[128:143]
    ds_read_b64_tr_b16 v[76:77], v26 offset:20480
    ds_read_b64_tr_b16 v[78:79], v27 offset:20480
    v_mfma_f32_32x32x16_bf16 v[144:159], v[196:199], v[180:183], v[144:159]
    s_waitcnt lgkmcnt(8)
    v_mfma_f32_32x32x16_bf16 v[80:95], v[48:51], v[40:43], v[80:95]
    ds_read_b128 v[160:163], v6 offset:49152
    ds_read_b64_tr_b16 v[168:169], v13 offset:29696
    v_mfma_f32_32x32x16_bf16 v[96:111], v[48:51], v[44:47], v[96:111]
    ds_read_b64_tr_b16 v[170:171], v13 offset:29984
    ds_read_b128 v[164:167], v10 offset:49152
    v_mfma_f32_32x32x16_bf16 v[112:127], v[52:55], v[40:43], v[112:127]
    ds_read_b64_tr_b16 v[172:173], v13 offset:29768
    ds_read_b64_tr_b16 v[174:175], v13 offset:30056
    v_mfma_f32_32x32x16_bf16 v[128:143], v[52:55], v[44:47], v[128:143]
    ds_read_b64_tr_b16 v[176:177], v28 offset:20480
    ds_read_b64_tr_b16 v[178:179], v29 offset:20480
    v_mfma_f32_32x32x16_bf16 v[144:159], v[56:59], v[40:43], v[144:159]
    s_waitcnt lgkmcnt(8)
    v_mfma_f32_32x32x16_bf16 v[80:95], v[68:71], v[60:63], v[80:95]
    ds_read_b128 v[180:183], v7 offset:49152
    ds_read_b64_tr_b16 v[188:189], v13 offset:34304
    v_mfma_f32_32x32x16_bf16 v[96:111], v[68:71], v[64:67], v[96:111]
    ds_read_b64_tr_b16 v[190:191], v13 offset:34592
    ds_read_b128 v[184:187], v11 offset:49152
    v_mfma_f32_32x32x16_bf16 v[112:127], v[72:75], v[60:63], v[112:127]
    ds_read_b64_tr_b16 v[192:193], v13 offset:34376
    ds_read_b64_tr_b16 v[194:195], v13 offset:34664
    v_mfma_f32_32x32x16_bf16 v[128:143], v[72:75], v[64:67], v[128:143]
    ds_read_b64_tr_b16 v[196:197], v30 offset:20480
    ds_read_b64_tr_b16 v[198:199], v31 offset:20480
    v_mfma_f32_32x32x16_bf16 v[144:159], v[76:79], v[60:63], v[144:159]
    s_waitcnt lgkmcnt(8)
    v_mfma_f32_32x32x16_bf16 v[80:95], v[168:171], v[160:163], v[80:95]
    s_barrier
    ds_read_b128 v[40:43], v4 offset:0
    ds_read_b64_tr_b16 v[48:49], v12 offset:0
    v_mfma_f32_32x32x16_bf16 v[96:111], v[168:171], v[164:167], v[96:111]
    ds_read_b64_tr_b16 v[50:51], v12 offset:288
    ds_read_b128 v[44:47], v8 offset:0
    v_mfma_f32_32x32x16_bf16 v[112:127], v[172:175], v[160:163], v[112:127]
    ds_read_b64_tr_b16 v[52:53], v12 offset:72
    ds_read_b64_tr_b16 v[54:55], v12 offset:360
    v_mfma_f32_32x32x16_bf16 v[128:143], v[172:175], v[164:167], v[128:143]
    ds_read_b64_tr_b16 v[56:57], v16 offset:0
    ds_read_b64_tr_b16 v[58:59], v17 offset:0
    v_mfma_f32_32x32x16_bf16 v[144:159], v[176:179], v[160:163], v[144:159]
    s_waitcnt lgkmcnt(8)
    v_mfma_f32_32x32x16_bf16 v[80:95], v[188:191], v[180:183], v[80:95]
    ds_read_b128 v[60:63], v5 offset:0
    ds_read_b64_tr_b16 v[68:69], v12 offset:4608
    v_mfma_f32_32x32x16_bf16 v[96:111], v[188:191], v[184:187], v[96:111]
    ds_read_b64_tr_b16 v[70:71], v12 offset:4896
    ds_read_b128 v[64:67], v9 offset:0
    v_mfma_f32_32x32x16_bf16 v[112:127], v[192:195], v[180:183], v[112:127]
    ds_read_b64_tr_b16 v[72:73], v12 offset:4680
    ds_read_b64_tr_b16 v[74:75], v12 offset:4968
    v_mfma_f32_32x32x16_bf16 v[128:143], v[192:195], v[184:187], v[128:143]
    ds_read_b64_tr_b16 v[76:77], v18 offset:0
    ds_read_b64_tr_b16 v[78:79], v19 offset:0
    v_mfma_f32_32x32x16_bf16 v[144:159], v[196:199], v[180:183], v[144:159]
    s_waitcnt lgkmcnt(8)
    v_mfma_f32_32x32x16_bf16 v[80:95], v[48:51], v[40:43], v[80:95]
    ds_read_b128 v[160:163], v6 offset:0
    ds_read_b64_tr_b16 v[168:169], v12 offset:9216
    v_mfma_f32_32x32x16_bf16 v[96:111], v[48:51], v[44:47], v[96:111]
    ds_read_b64_tr_b16 v[170:171], v12 offset:9504
    ds_read_b128 v[164:167], v10 offset:0
    v_mfma_f32_32x32x16_bf16 v[112:127], v[52:55], v[40:43], v[112:127]
    ds_read_b64_tr_b16 v[172:173], v12 offset:9288
    ds_read_b64_tr_b16 v[174:175], v12 offset:9576
    v_mfma_f32_32x32x16_bf16 v[128:143], v[52:55], v[44:47], v[128:143]
    ds_read_b64_tr_b16 v[176:177], v20 offset:0
    ds_read_b64_tr_b16 v[178:179], v21 offset:0
    v_mfma_f32_32x32x16_bf16 v[144:159], v[56:59], v[40:43], v[144:159]
    s_waitcnt lgkmcnt(8)
    v_mfma_f32_32x32x16_bf16 v[80:95], v[68:71], v[60:63], v[80:95]
    ds_read_b128 v[180:183], v7 offset:0
    ds_read_b64_tr_b16 v[188:189], v12 offset:13824
    v_mfma_f32_32x32x16_bf16 v[96:111], v[68:71], v[64:67], v[96:111]
    ds_read_b64_tr_b16 v[190:191], v12 offset:14112
    ds_read_b128 v[184:187], v11 offset:0
    v_mfma_f32_32x32x16_bf16 v[112:127], v[72:75], v[60:63], v[112:127]
    ds_read_b64_tr_b16 v[192:193], v12 offset:13896
    ds_read_b64_tr_b16 v[194:195], v12 offset:14184
    v_mfma_f32_32x32x16_bf16 v[128:143], v[72:75], v[64:67], v[128:143]
    ds_read_b64_tr_b16 v[196:197], v22 offset:0
    ds_read_b64_tr_b16 v[198:199], v23 offset:0
    v_mfma_f32_32x32x16_bf16 v[144:159], v[76:79], v[60:63], v[144:159]
    s_waitcnt lgkmcnt(8)
    v_mfma_f32_32x32x16_bf16 v[80:95], v[168:171], v[160:163], v[80:95]
    s_barrier
    ds_read_b128 v[40:43], v4 offset:16384
    ds_read_b64_tr_b16 v[48:49], v12 offset:20480
    v_mfma_f32_32x32x16_bf16 v[96:111], v[168:171], v[164:167], v[96:111]
    ds_read_b64_tr_b16 v[50:51], v12 offset:20768
    ds_read_b128 v[44:47], v8 offset:16384
    v_mfma_f32_32x32x16_bf16 v[112:127], v[172:175], v[160:163], v[112:127]
    ds_read_b64_tr_b16 v[52:53], v12 offset:20552
    ds_read_b64_tr_b16 v[54:55], v12 offset:20840
    v_mfma_f32_32x32x16_bf16 v[128:143], v[172:175], v[164:167], v[128:143]
    ds_read_b64_tr_b16 v[56:57], v16 offset:20480
    ds_read_b64_tr_b16 v[58:59], v17 offset:20480
    v_mfma_f32_32x32x16_bf16 v[144:159], v[176:179], v[160:163], v[144:159]
    s_waitcnt lgkmcnt(8)
    v_mfma_f32_32x32x16_bf16 v[80:95], v[188:191], v[180:183], v[80:95]
    ds_read_b128 v[60:63], v5 offset:16384
    ds_read_b64_tr_b16 v[68:69], v12 offset:25088
    v_mfma_f32_32x32x16_bf16 v[96:111], v[188:191], v[184:187], v[96:111]
    ds_read_b64_tr_b16 v[70:71], v12 offset:25376
    ds_read_b128 v[64:67], v9 offset:16384
    v_mfma_f32_32x32x16_bf16 v[112:127], v[192:195], v[180:183], v[112:127]
    ds_read_b64_tr_b16 v[72:73], v12 offset:25160
    ds_read_b64_tr_b16 v[74:75], v12 offset:25448
    v_mfma_f32_32x32x16_bf16 v[128:143], v[192:195], v[184:187], v[128:143]
    ds_read_b64_tr_b16 v[76:77], v18 offset:20480
    ds_read_b64_tr_b16 v[78:79], v19 offset:20480
    v_mfma_f32_32x32x16_bf16 v[144:159], v[196:199], v[180:183], v[144:159]
    s_waitcnt lgkmcnt(8)
    v_mfma_f32_32x32x16_bf16 v[80:95], v[48:51], v[40:43], v[80:95]
    ds_read_b128 v[160:163], v6 offset:16384
    ds_read_b64_tr_b16 v[168:169], v12 offset:29696
    v_mfma_f32_32x32x16_bf16 v[96:111], v[48:51], v[44:47], v[96:111]
    ds_read_b64_tr_b16 v[170:171], v12 offset:29984
    ds_read_b128 v[164:167], v10 offset:16384
    v_mfma_f32_32x32x16_bf16 v[112:127], v[52:55], v[40:43], v[112:127]
    ds_read_b64_tr_b16 v[172:173], v12 offset:29768
    ds_read_b64_tr_b16 v[174:175], v12 offset:30056
    v_mfma_f32_32x32x16_bf16 v[128:143], v[52:55], v[44:47], v[128:143]
    ds_read_b64_tr_b16 v[176:177], v20 offset:20480
    ds_read_b64_tr_b16 v[178:179], v21 offset:20480
    v_mfma_f32_32x32x16_bf16 v[144:159], v[56:59], v[40:43], v[144:159]
    s_waitcnt lgkmcnt(8)
    v_mfma_f32_32x32x16_bf16 v[80:95], v[68:71], v[60:63], v[80:95]
    ds_read_b128 v[180:183], v7 offset:16384
    ds_read_b64_tr_b16 v[188:189], v12 offset:34304
    v_mfma_f32_32x32x16_bf16 v[96:111], v[68:71], v[64:67], v[96:111]
    ds_read_b64_tr_b16 v[190:191], v12 offset:34592
    ds_read_b128 v[184:187], v11 offset:16384
    v_mfma_f32_32x32x16_bf16 v[112:127], v[72:75], v[60:63], v[112:127]
    ds_read_b64_tr_b16 v[192:193], v12 offset:34376
    ds_read_b64_tr_b16 v[194:195], v12 offset:34664
    v_mfma_f32_32x32x16_bf16 v[128:143], v[72:75], v[64:67], v[128:143]
    ds_read_b64_tr_b16 v[196:197], v22 offset:20480
    ds_read_b64_tr_b16 v[198:199], v23 offset:20480
    v_mfma_f32_32x32x16_bf16 v[144:159], v[76:79], v[60:63], v[144:159]
    s_waitcnt lgkmcnt(8)
    v_mfma_f32_32x32x16_bf16 v[80:95], v[168:171], v[160:163], v[80:95]
    s_barrier
    ds_read_b128 v[40:43], v4 offset:32768
    ds_read_b64_tr_b16 v[48:49], v13 offset:0
    v_mfma_f32_32x32x16_bf16 v[96:111], v[168:171], v[164:167], v[96:111]
    ds_read_b64_tr_b16 v[50:51], v13 offset:288
    ds_read_b128 v[44:47], v8 offset:32768
    v_mfma_f32_32x32x16_bf16 v[112:127], v[172:175], v[160:163], v[112:127]
    ds_read_b64_tr_b16 v[52:53], v13 offset:72
    ds_read_b64_tr_b16 v[54:55], v13 offset:360
    v_mfma_f32_32x32x16_bf16 v[128:143], v[172:175], v[164:167], v[128:143]
    ds_read_b64_tr_b16 v[56:57], v24 offset:0
    ds_read_b64_tr_b16 v[58:59], v25 offset:0
    v_mfma_f32_32x32x16_bf16 v[144:159], v[176:179], v[160:163], v[144:159]
    s_waitcnt lgkmcnt(8)
    v_mfma_f32_32x32x16_bf16 v[80:95], v[188:191], v[180:183], v[80:95]
    ds_read_b128 v[60:63], v5 offset:32768
    ds_read_b64_tr_b16 v[68:69], v13 offset:4608
    v_mfma_f32_32x32x16_bf16 v[96:111], v[188:191], v[184:187], v[96:111]
    ds_read_b64_tr_b16 v[70:71], v13 offset:4896
    ds_read_b128 v[64:67], v9 offset:32768
    v_mfma_f32_32x32x16_bf16 v[112:127], v[192:195], v[180:183], v[112:127]
    ds_read_b64_tr_b16 v[72:73], v13 offset:4680
    ds_read_b64_tr_b16 v[74:75], v13 offset:4968
    v_mfma_f32_32x32x16_bf16 v[128:143], v[192:195], v[184:187], v[128:143]
    ds_read_b64_tr_b16 v[76:77], v26 offset:0
    ds_read_b64_tr_b16 v[78:79], v27 offset:0
    v_mfma_f32_32x32x16_bf16 v[144:159], v[196:199], v[180:183], v[144:159]
    s_waitcnt lgkmcnt(8)
    v_mfma_f32_32x32x16_bf16 v[80:95], v[48:51], v[40:43], v[80:95]
    ds_read_b128 v[160:163], v6 offset:32768
    ds_read_b64_tr_b16 v[168:169], v13 offset:9216
    v_mfma_f32_32x32x16_bf16 v[96:111], v[48:51], v[44:47], v[96:111]
    ds_read_b64_tr_b16 v[170:171], v13 offset:9504
    ds_read_b128 v[164:167], v10 offset:32768
    v_mfma_f32_32x32x16_bf16 v[112:127], v[52:55], v[40:43], v[112:127]
    ds_read_b64_tr_b16 v[172:173], v13 offset:9288
    ds_read_b64_tr_b16 v[174:175], v13 offset:9576
    v_mfma_f32_32x32x16_bf16 v[128:143], v[52:55], v[44:47], v[128:143]
    ds_read_b64_tr_b16 v[176:177], v28 offset:0
    ds_read_b64_tr_b16 v[178:179], v29 offset:0
    v_mfma_f32_32x32x16_bf16 v[144:159], v[56:59], v[40:43], v[144:159]
    s_waitcnt lgkmcnt(8)
    v_mfma_f32_32x32x16_bf16 v[80:95], v[68:71], v[60:63], v[80:95]
    ds_read_b128 v[180:183], v7 offset:32768
    ds_read_b64_tr_b16 v[188:189], v13 offset:13824
    v_mfma_f32_32x32x16_bf16 v[96:111], v[68:71], v[64:67], v[96:111]
    ds_read_b64_tr_b16 v[190:191], v13 offset:14112
    ds_read_b128 v[184:187], v11 offset:32768
    v_mfma_f32_32x32x16_bf16 v[112:127], v[72:75], v[60:63], v[112:127]
    ds_read_b64_tr_b16 v[192:193], v13 offset:13896
    ds_read_b64_tr_b16 v[194:195], v13 offset:14184
    v_mfma_f32_32x32x16_bf16 v[128:143], v[72:75], v[64:67], v[128:143]
    ds_read_b64_tr_b16 v[196:197], v30 offset:0
    ds_read_b64_tr_b16 v[198:199], v31 offset:0
    v_mfma_f32_32x32x16_bf16 v[144:159], v[76:79], v[60:63], v[144:159]
    s_waitcnt lgkmcnt(8)
    v_mfma_f32_32x32x16_bf16 v[80:95], v[168:171], v[160:163], v[80:95]
    s_barrier
    ds_read_b128 v[40:43], v4 offset:49152
    ds_read_b64_tr_b16 v[48:49], v13 offset:20480
    v_mfma_f32_32x32x16_bf16 v[96:111], v[168:171], v[164:167], v[96:111]
    ds_read_b64_tr_b16 v[50:51], v13 offset:20768
    ds_read_b128 v[44:47], v8 offset:49152
    v_mfma_f32_32x32x16_bf16 v[112:127], v[172:175], v[160:163], v[112:127]
    ds_read_b64_tr_b16 v[52:53], v13 offset:20552
    ds_read_b64_tr_b16 v[54:55], v13 offset:20840
    v_mfma_f32_32x32x16_bf16 v[128:143], v[172:175], v[164:167], v[128:143]
    ds_read_b64_tr_b16 v[56:57], v24 offset:20480
    ds_read_b64_tr_b16 v[58:59], v25 offset:20480
    v_mfma_f32_32x32x16_bf16 v[144:159], v[176:179], v[160:163], v[144:159]
    s_waitcnt lgkmcnt(8)
    v_mfma_f32_32x32x16_bf16 v[80:95], v[188:191], v[180:183], v[80:95]
    ds_read_b128 v[60:63], v5 offset:49152
    ds_read_b64_tr_b16 v[68:69], v13 offset:25088
    v_mfma_f32_32x32x16_bf16 v[96:111], v[188:191], v[184:187], v[96:111]
    ds_read_b64_tr_b16 v[70:71], v13 offset:25376
    ds_read_b128 v[64:67], v9 offset:49152
    v_mfma_f32_32x32x16_bf16 v[112:127], v[192:195], v[180:183], v[112:127]
    ds_read_b64_tr_b16 v[72:73], v13 offset:25160
    ds_read_b64_tr_b16 v[74:75], v13 offset:25448
    v_mfma_f32_32x32x16_bf16 v[128:143], v[192:195], v[184:187], v[128:143]
    ds_read_b64_tr_b16 v[76:77], v26 offset:20480
    ds_read_b64_tr_b16 v[78:79], v27 offset:20480
    v_mfma_f32_32x32x16_bf16 v[144:159], v[196:199], v[180:183], v[144:159]
    s_waitcnt lgkmcnt(8)
    v_mfma_f32_32x32x16_bf16 v[80:95], v[48:51], v[40:43], v[80:95]
    ds_read_b128 v[160:163], v6 offset:49152
    ds_read_b64_tr_b16 v[168:169], v13 offset:29696
    v_mfma_f32_32x32x16_bf16 v[96:111], v[48:51], v[44:47], v[96:111]
    ds_read_b64_tr_b16 v[170:171], v13 offset:29984
    ds_read_b128 v[164:167], v10 offset:49152
    v_mfma_f32_32x32x16_bf16 v[112:127], v[52:55], v[40:43], v[112:127]
    ds_read_b64_tr_b16 v[172:173], v13 offset:29768
    ds_read_b64_tr_b16 v[174:175], v13 offset:30056
    v_mfma_f32_32x32x16_bf16 v[128:143], v[52:55], v[44:47], v[128:143]
    ds_read_b64_tr_b16 v[176:177], v28 offset:20480
    ds_read_b64_tr_b16 v[178:179], v29 offset:20480
    v_mfma_f32_32x32x16_bf16 v[144:159], v[56:59], v[40:43], v[144:159]
    s_waitcnt lgkmcnt(8)
    v_mfma_f32_32x32x16_bf16 v[80:95], v[68:71], v[60:63], v[80:95]
    ds_read_b128 v[180:183], v7 offset:49152
    ds_read_b64_tr_b16 v[188:189], v13 offset:34304
    v_mfma_f32_32x32x16_bf16 v[96:111], v[68:71], v[64:67], v[96:111]
    ds_read_b64_tr_b16 v[190:191], v13 offset:34592
    ds_read_b128 v[184:187], v11 offset:49152
    v_mfma_f32_32x32x16_bf16 v[112:127], v[72:75], v[60:63], v[112:127]
    ds_read_b64_tr_b16 v[192:193], v13 offset:34376
    ds_read_b64_tr_b16 v[194:195], v13 offset:34664
    v_mfma_f32_32x32x16_bf16 v[128:143], v[72:75], v[64:67], v[128:143]
    ds_read_b64_tr_b16 v[196:197], v30 offset:20480
    ds_read_b64_tr_b16 v[198:199], v31 offset:20480
    v_mfma_f32_32x32x16_bf16 v[144:159], v[76:79], v[60:63], v[144:159]
    s_waitcnt lgkmcnt(8)
    v_mfma_f32_32x32x16_bf16 v[80:95], v[168:171], v[160:163], v[80:95]
    s_barrier
    ds_read_b128 v[40:43], v4 offset:0
    ds_read_b64_tr_b16 v[48:49], v12 offset:0
    v_mfma_f32_32x32x16_bf16 v[96:111], v[168:171], v[164:167], v[96:111]
    ds_read_b64_tr_b16 v[50:51], v12 offset:288
    ds_read_b128 v[44:47], v8 offset:0
    v_mfma_f32_32x32x16_bf16 v[112:127], v[172:175], v[160:163], v[112:127]
    ds_read_b64_tr_b16 v[52:53], v12 offset:72
    ds_read_b64_tr_b16 v[54:55], v12 offset:360
    v_mfma_f32_32x32x16_bf16 v[128:143], v[172:175], v[164:167], v[128:143]
    ds_read_b64_tr_b16 v[56:57], v16 offset:0
    ds_read_b64_tr_b16 v[58:59], v17 offset:0
    v_mfma_f32_32x32x16_bf16 v[144:159], v[176:179], v[160:163], v[144:159]
    s_waitcnt lgkmcnt(8)
    v_mfma_f32_32x32x16_bf16 v[80:95], v[188:191], v[180:183], v[80:95]
    ds_read_b128 v[60:63], v5 offset:0
    ds_read_b64_tr_b16 v[68:69], v12 offset:4608
    v_mfma_f32_32x32x16_bf16 v[96:111], v[188:191], v[184:187], v[96:111]
    ds_read_b64_tr_b16 v[70:71], v12 offset:4896
    ds_read_b128 v[64:67], v9 offset:0
    v_mfma_f32_32x32x16_bf16 v[112:127], v[192:195], v[180:183], v[112:127]
    ds_read_b64_tr_b16 v[72:73], v12 offset:4680
    ds_read_b64_tr_b16 v[74:75], v12 offset:4968
    v_mfma_f32_32x32x16_bf16 v[128:143], v[192:195], v[184:187], v[128:143]
    ds_read_b64_tr_b16 v[76:77], v18 offset:0
    ds_read_b64_tr_b16 v[78:79], v19 offset:0
    v_mfma_f32_32x32x16_bf16 v[144:159], v[196:199], v[180:183], v[144:159]
    s_waitcnt lgkmcnt(7)
    v_mfma_f32_32x32x16_bf16 v[80:95], v[48:51], v[40:43], v[80:95]
    ds_read_b128 v[160:163], v6 offset:0
    ds_read_b64_tr_b16 v[168:169], v12 offset:9216
    ds_read_b64_tr_b16 v[170:171], v12 offset:9504
    ds_read_b128 v[164:167], v10 offset:0
    ds_read_b64_tr_b16 v[172:173], v12 offset:9288
    ds_read_b64_tr_b16 v[174:175], v12 offset:9576
    ds_read_b64_tr_b16 v[176:177], v20 offset:0
    ds_read_b64_tr_b16 v[178:179], v21 offset:0
    v_mfma_f32_32x32x16_bf16 v[96:111], v[48:51], v[44:47], v[96:111]
    s_waitcnt lgkmcnt(7)
    v_mfma_f32_32x32x16_bf16 v[80:95], v[68:71], v[60:63], v[80:95]
    ds_read_b128 v[180:183], v7 offset:0
    ds_read_b64_tr_b16 v[188:189], v12 offset:13824
    ds_read_b64_tr_b16 v[190:191], v12 offset:14112
    ds_read_b128 v[184:187], v11 offset:0
    ds_read_b64_tr_b16 v[192:193], v12 offset:13896
    ds_read_b64_tr_b16 v[194:195], v12 offset:14184
    ds_read_b64_tr_b16 v[196:197], v22 offset:0
    ds_read_b64_tr_b16 v[198:199], v23 offset:0
    v_mfma_f32_32x32x16_bf16 v[96:111], v[68:71], v[64:67], v[96:111]
    s_waitcnt lgkmcnt(8)
    v_mfma_f32_32x32x16_bf16 v[80:95], v[168:171], v[160:163], v[80:95]
    v_mfma_f32_32x32x16_bf16 v[112:127], v[52:55], v[40:43], v[112:127]
    s_waitcnt lgkmcnt(0)
    v_mfma_f32_32x32x16_bf16 v[80:95], v[188:191], v[180:183], v[80:95]
    v_mfma_f32_32x32x16_bf16 v[96:111], v[168:171], v[164:167], v[96:111]
    v_mfma_f32_32x32x16_bf16 v[96:111], v[188:191], v[184:187], v[96:111]
    s_nop 9
    v_pk_mul_f32 v[80:81], v[80:81], s[46:47]
    v_pk_mul_f32 v[82:83], v[82:83], s[46:47]
    v_pk_mul_f32 v[84:85], v[84:85], s[46:47]
    v_pk_mul_f32 v[86:87], v[86:87], s[46:47]
    v_cvt_pk_bf16_f32 v200, v80, v81
    v_cvt_pk_bf16_f32 v201, v82, v83
    v_cvt_pk_bf16_f32 v202, v84, v85
    v_mfma_f32_32x32x16_bf16 v[112:127], v[72:75], v[60:63], v[112:127]
    v_cvt_pk_bf16_f32 v203, v86, v87
    s_add_u32 s50, s58, 0
    buffer_store_dwordx4 v[200:203], v32, s[24:27], s50 offen sc1
    v_pk_mul_f32 v[88:89], v[88:89], s[46:47]
    v_pk_mul_f32 v[90:91], v[90:91], s[46:47]
    v_pk_mul_f32 v[92:93], v[92:93], s[46:47]
    v_pk_mul_f32 v[94:95], v[94:95], s[46:47]
    v_cvt_pk_bf16_f32 v204, v88, v89
    v_cvt_pk_bf16_f32 v205, v90, v91
    v_cvt_pk_bf16_f32 v206, v92, v93
    v_cvt_pk_bf16_f32 v207, v94, v95
    s_add_u32 s50, s58, 73728
    buffer_store_dwordx4 v[204:207], v32, s[24:27], s50 offen sc1
    v_mfma_f32_32x32x16_bf16 v[112:127], v[172:175], v[160:163], v[112:127]
    v_pk_mul_f32 v[96:97], v[96:97], s[46:47]
    v_pk_mul_f32 v[98:99], v[98:99], s[46:47]
    v_pk_mul_f32 v[100:101], v[100:101], s[46:47]
    v_pk_mul_f32 v[102:103], v[102:103], s[46:47]
    v_cvt_pk_bf16_f32 v208, v96, v97
    v_cvt_pk_bf16_f32 v209, v98, v99
    v_cvt_pk_bf16_f32 v210, v100, v101
    v_mfma_f32_32x32x16_bf16 v[112:127], v[192:195], v[180:183], v[112:127]
    v_cvt_pk_bf16_f32 v211, v102, v103
    s_add_u32 s50, s59, 0
    buffer_store_dwordx4 v[208:211], v32, s[24:27], s50 offen sc1
    v_pk_mul_f32 v[104:105], v[104:105], s[46:47]
    v_pk_mul_f32 v[106:107], v[106:107], s[46:47]
    v_pk_mul_f32 v[108:109], v[108:109], s[46:47]
    v_pk_mul_f32 v[110:111], v[110:111], s[46:47]
    v_mfma_f32_32x32x16_bf16 v[128:143], v[52:55], v[44:47], v[128:143]
    v_cvt_pk_bf16_f32 v212, v104, v105
    v_cvt_pk_bf16_f32 v213, v106, v107
    v_cvt_pk_bf16_f32 v214, v108, v109
    v_cvt_pk_bf16_f32 v215, v110, v111
    s_add_u32 s50, s59, 73728
    buffer_store_dwordx4 v[212:215], v32, s[24:27], s50 offen sc1
    v_mfma_f32_32x32x16_bf16 v[128:143], v[72:75], v[64:67], v[128:143]
    s_nop 1
    v_pk_mul_f32 v[112:113], v[112:113], s[46:47]
    v_pk_mul_f32 v[114:115], v[114:115], s[46:47]
    v_pk_mul_f32 v[116:117], v[116:117], s[46:47]
    v_pk_mul_f32 v[118:119], v[118:119], s[46:47]
    v_cvt_pk_bf16_f32 v216, v112, v113
    v_cvt_pk_bf16_f32 v217, v114, v115
    v_cvt_pk_bf16_f32 v218, v116, v117
    v_mfma_f32_32x32x16_bf16 v[128:143], v[172:175], v[164:167], v[128:143]
    v_cvt_pk_bf16_f32 v219, v118, v119
    s_add_u32 s50, s58, 147456
    buffer_store_dwordx4 v[216:219], v32, s[24:27], s50 offen sc1
    v_pk_mul_f32 v[120:121], v[120:121], s[46:47]
    v_pk_mul_f32 v[122:123], v[122:123], s[46:47]
    v_pk_mul_f32 v[124:125], v[124:125], s[46:47]
    v_pk_mul_f32 v[126:127], v[126:127], s[46:47]
    v_mfma_f32_32x32x16_bf16 v[128:143], v[192:195], v[184:187], v[128:143]
    v_cvt_pk_bf16_f32 v220, v120, v121
    v_cvt_pk_bf16_f32 v221, v122, v123
    v_cvt_pk_bf16_f32 v222, v124, v125
    v_cvt_pk_bf16_f32 v223, v126, v127
    s_add_u32 s50, s58, 221184
    buffer_store_dwordx4 v[220:223], v32, s[24:27], s50 offen sc1
    v_mfma_f32_32x32x16_bf16 v[144:159], v[56:59], v[40:43], v[144:159]
    v_mfma_f32_32x32x16_bf16 v[144:159], v[76:79], v[60:63], v[144:159]
    s_nop 5
    v_pk_mul_f32 v[128:129], v[128:129], s[46:47]
    v_pk_mul_f32 v[130:131], v[130:131], s[46:47]
    v_pk_mul_f32 v[132:133], v[132:133], s[46:47]
    v_pk_mul_f32 v[134:135], v[134:135], s[46:47]
    v_cvt_pk_bf16_f32 v224, v128, v129
    v_cvt_pk_bf16_f32 v225, v130, v131
    v_cvt_pk_bf16_f32 v226, v132, v133
    v_mfma_f32_32x32x16_bf16 v[144:159], v[176:179], v[160:163], v[144:159]
    v_cvt_pk_bf16_f32 v227, v134, v135
    s_add_u32 s50, s59, 147456
    buffer_store_dwordx4 v[224:227], v32, s[24:27], s50 offen sc1
    v_pk_mul_f32 v[136:137], v[136:137], s[46:47]
    v_pk_mul_f32 v[138:139], v[138:139], s[46:47]
    v_pk_mul_f32 v[140:141], v[140:141], s[46:47]
    v_pk_mul_f32 v[142:143], v[142:143], s[46:47]
    v_mfma_f32_32x32x16_bf16 v[144:159], v[196:199], v[180:183], v[144:159]
    v_cvt_pk_bf16_f32 v228, v136, v137
    v_cvt_pk_bf16_f32 v229, v138, v139
    v_cvt_pk_bf16_f32 v230, v140, v141
    v_cvt_pk_bf16_f32 v231, v142, v143
    s_add_u32 s50, s59, 221184
    buffer_store_dwordx4 v[228:231], v32, s[24:27], s50 offen sc1
    s_nop 11
    v_pk_mul_f32 v[144:145], v[144:145], s[46:47]
    v_pk_mul_f32 v[146:147], v[146:147], s[46:47]
    v_pk_mul_f32 v[148:149], v[148:149], s[46:47]
    v_pk_mul_f32 v[150:151], v[150:151], s[46:47]
    v_cvt_pk_bf16_f32 v232, v144, v145
    v_cvt_pk_bf16_f32 v233, v146, v147
    v_cvt_pk_bf16_f32 v234, v148, v149
    v_cvt_pk_bf16_f32 v235, v150, v151
    s_add_u32 s50, s49, 0
    buffer_store_dword v232, v33, s[24:27], s50 offen sc1
    s_add_u32 s50, s49, 73728
    buffer_store_dword v233, v33, s[24:27], s50 offen sc1
    s_add_u32 s50, s49, 294912
    buffer_store_dword v234, v33, s[24:27], s50 offen sc1
    s_add_u32 s50, s49, 368640
    buffer_store_dword v235, v33, s[24:27], s50 offen sc1
    s_and_b32 s45, s33, 14
    s_cmp_eq_u32 s45, 4
    s_cbranch_scc0 L1_end
    v_cvt_pk_bf16_f32 v236, v152, v153
    v_cvt_pk_bf16_f32 v237, v154, v155
    v_cvt_pk_bf16_f32 v238, v156, v157
    v_cvt_pk_bf16_f32 v239, v158, v159
    s_and_b32 s45, s33, 1
    s_mul_i32 s46, s45, 73728
    s_add_u32 s44, s53, 2359296
    s_add_u32 s48, s44, s46
    s_lshl_b32 s47, s54, 10
    s_add_u32 s48, s48, s47
    buffer_store_dwordx4 v[236:239], v32, s[24:27], s48 offen sc1
    s_sub_u32 s48, s44, s46
    s_add_u32 s48, s48, 81920
    s_lshl_b32 s47, s54, 7
    s_add_u32 s48, s48, s47
    v_cmp_eq_u32 vcc, s45, v3
    v_mov_b32 v30, 0x7ff00000
    s_nop 0
    v_cndmask_b32 v30, v30, v34, vcc
    v_cmp_eq_u32 vcc, 0, v3
    s_nop 1
    v_cndmask_b32 v31, v239, v236, vcc
    buffer_store_dword v31, v30, s[24:27], s48 offen sc1
    s_endpgm

L1_vtype:
    v_and_b32 v48, 0x13, v2
    v_and_b32 v49, 4, v2
    v_lshl_or_b32 v48, v49, 1, v48
    v_and_b32 v49, 8, v2
    v_lshrrev_b32 v49, 1, v49
    v_or_b32 v48, v48, v49

    v_lshrrev_b32 v46, 1, v48
    v_and_b32 v46, 7, v46
    v_xor_b32 v46, v46, v3
    s_lshl_b32 s44, s38, 12
    s_add_u32 s44, s44, 81920
    v_lshlrev_b32 v47, 7, v48
    v_add_u32 v47, s44, v47

    v_xor_b32 v4, 0, v46
    v_lshl_add_u32 v4, v4, 4, v47
    v_xor_b32 v8, 0x1000, v4
    v_xor_b32 v5, 2, v46
    v_lshl_add_u32 v5, v5, 4, v47
    v_xor_b32 v9, 0x1000, v5
    v_xor_b32 v6, 4, v46
    v_lshl_add_u32 v6, v6, 4, v47
    v_xor_b32 v10, 0x1000, v6
    v_xor_b32 v7, 6, v46
    v_lshl_add_u32 v7, v7, 4, v47
    v_xor_b32 v11, 0x1000, v7
    s_lshl_b32 s44, s37, 7
    v_lshl_add_u32 v48, v44, 3, v42
    v_add_u32 v12, s44, v48
    v_add_u32 v13, 40960, v12
    v_add_u32 v48, 256, v48
    v_lshl_add_u32 v49, v44, 3, v43
    v_add_u32 v49, 18400, v49

    v_cmp_gt_u32 vcc, 4, v44
    v_add_u32 v46, 0, v48
    v_add_u32 v47, 0, v49
    v_cndmask_b32 v16, v47, v46, vcc
    v_add_u32 v24, 40960, v16
    v_add_u32 v46, 288, v48
    v_add_u32 v47, 128, v49
    v_cndmask_b32 v17, v47, v46, vcc
    v_add_u32 v25, 40960, v17
    v_add_u32 v46, 4608, v48
    v_add_u32 v47, 512, v49
    v_cndmask_b32 v18, v47, v46, vcc
    v_add_u32 v26, 40960, v18
    v_add_u32 v46, 4896, v48
    v_add_u32 v47, 640, v49
    v_cndmask_b32 v19, v47, v46, vcc
    v_add_u32 v27, 40960, v19
    v_add_u32 v46, 9216, v48
    v_add_u32 v47, 1024, v49
    v_cndmask_b32 v20, v47, v46, vcc
    v_add_u32 v28, 40960, v20
    v_add_u32 v46, 9504, v48
    v_add_u32 v47, 1152, v49
    v_cndmask_b32 v21, v47, v46, vcc
    v_add_u32 v29, 40960, v21
    v_add_u32 v46, 13824, v48
    v_add_u32 v47, 1536, v49
    v_cndmask_b32 v22, v47, v46, vcc
    v_add_u32 v30, 40960, v22
    v_add_u32 v46, 14112, v48
    v_add_u32 v47, 1664, v49
    v_cndmask_b32 v23, v47, v46, vcc
    v_add_u32 v31, 40960, v23
    s_and_b32 s45, s33, 3
    s_mul_i32 s46, s45, 2304
    s_mul_i32 s60, s52, 39424
    s_add_u32 s60, s60, 7225344
    s_add_u32 s58, s60, s46
    s_xor_b32 s47, s52, 1
    s_mul_i32 s59, s47, 39424
    s_add_u32 s59, s59, 7225344
    s_add_u32 s59, s59, s46
    s_lshl_b32 s44, s37, 10
    v_mul_u32_u24 v46, 9856, v3
    v_lshl_add_u32 v46, v2, 4, v46
    v_add_u32 v32, s44, v46
    s_lshl_b32 s47, s45, 8
    s_add_u32 s47, s47, 8960
    s_sub_u32 s47, s47, s46
    s_cmp_lt_u32 s45, 2
    s_cselect_b32 s47, s47, 0x7ff00000
    v_add_u32 v47, s47, v46
    v_add_u32 v46, 2048, v46
    v_cmp_gt_u32 vcc, 16, v2
    v_lshrrev_b32 v48, 3, v1
    v_mul_u32_u24 v48, 9856, v48
    v_cndmask_b32 v33, v47, v46, vcc
    v_and_b32 v49, 7, v1
    v_lshl_add_u32 v48, v49, 4, v48
    v_add_u32 v48, 9728, v48
    v_mov_b32 v49, 0x7ff00000
    v_cmp_gt_u32 vcc, 32, v1
    v_mov_b32 v52, 0x3f803f80
    v_mov_b32 v53, 0x3f803f80
    v_mov_b32 v54, 0x3f803f80
    v_mov_b32 v55, 0x3f803f80
    v_cndmask_b32 v48, v49, v48, vcc
    s_cmp_eq_u32 s45, 2
    s_cbranch_scc0 L1_noones
    buffer_store_dwordx4 v[52:55], v48, s[24:27], s60 offen sc1

L1_noones:
    s_barrier
    ds_read_b128 v[40:43], v4 offset:0
    ds_read_b64_tr_b16 v[48:49], v12 offset:0
    ds_read_b64_tr_b16 v[50:51], v12 offset:288
    ds_read_b128 v[44:47], v8 offset:0
    ds_read_b64_tr_b16 v[52:53], v12 offset:64
    ds_read_b64_tr_b16 v[54:55], v12 offset:352
    ds_read_b64_tr_b16 v[56:57], v16 offset:0
    ds_read_b64_tr_b16 v[58:59], v17 offset:0
    ds_read_b128 v[60:63], v5 offset:0
    ds_read_b64_tr_b16 v[68:69], v12 offset:4608
    ds_read_b64_tr_b16 v[70:71], v12 offset:4896
    ds_read_b128 v[64:67], v9 offset:0
    ds_read_b64_tr_b16 v[72:73], v12 offset:4672
    ds_read_b64_tr_b16 v[74:75], v12 offset:4960
    ds_read_b64_tr_b16 v[76:77], v18 offset:0
    s_waitcnt lgkmcnt(7)
    ds_read_b64_tr_b16 v[78:79], v19 offset:0
    v_mfma_f32_32x32x16_bf16 v[80:95], v[40:43], v[48:51], 0
    ds_read_b128 v[160:163], v6 offset:0
    ds_read_b64_tr_b16 v[168:169], v12 offset:9216
    v_mfma_f32_32x32x16_bf16 v[96:111], v[44:47], v[48:51], 0
    ds_read_b64_tr_b16 v[170:171], v12 offset:9504
    ds_read_b128 v[164:167], v10 offset:0
    v_mfma_f32_32x32x16_bf16 v[112:127], v[40:43], v[52:55], 0
    ds_read_b64_tr_b16 v[172:173], v12 offset:9280
    ds_read_b64_tr_b16 v[174:175], v12 offset:9568
    v_mfma_f32_32x32x16_bf16 v[128:143], v[44:47], v[52:55], 0
    ds_read_b64_tr_b16 v[176:177], v20 offset:0
    ds_read_b64_tr_b16 v[178:179], v21 offset:0
    v_mfma_f32_32x32x16_bf16 v[144:159], v[40:43], v[56:59], 0
    s_waitcnt lgkmcnt(8)
    v_mfma_f32_32x32x16_bf16 v[80:95], v[60:63], v[68:71], v[80:95]
    ds_read_b128 v[180:183], v7 offset:0
    ds_read_b64_tr_b16 v[188:189], v12 offset:13824
    v_mfma_f32_32x32x16_bf16 v[96:111], v[64:67], v[68:71], v[96:111]
    ds_read_b64_tr_b16 v[190:191], v12 offset:14112
    ds_read_b128 v[184:187], v11 offset:0
    v_mfma_f32_32x32x16_bf16 v[112:127], v[60:63], v[72:75], v[112:127]
    ds_read_b64_tr_b16 v[192:193], v12 offset:13888
    ds_read_b64_tr_b16 v[194:195], v12 offset:14176
    v_mfma_f32_32x32x16_bf16 v[128:143], v[64:67], v[72:75], v[128:143]
    ds_read_b64_tr_b16 v[196:197], v22 offset:0
    ds_read_b64_tr_b16 v[198:199], v23 offset:0
    v_mfma_f32_32x32x16_bf16 v[144:159], v[60:63], v[76:79], v[144:159]
    s_waitcnt lgkmcnt(8)
    v_mfma_f32_32x32x16_bf16 v[80:95], v[160:163], v[168:171], v[80:95]
    s_barrier
    ds_read_b128 v[40:43], v4 offset:16384
    ds_read_b64_tr_b16 v[48:49], v12 offset:20480
    v_mfma_f32_32x32x16_bf16 v[96:111], v[164:167], v[168:171], v[96:111]
    ds_read_b64_tr_b16 v[50:51], v12 offset:20768
    ds_read_b128 v[44:47], v8 offset:16384
    v_mfma_f32_32x32x16_bf16 v[112:127], v[160:163], v[172:175], v[112:127]
    ds_read_b64_tr_b16 v[52:53], v12 offset:20544
    ds_read_b64_tr_b16 v[54:55], v12 offset:20832
    v_mfma_f32_32x32x16_bf16 v[128:143], v[164:167], v[172:175], v[128:143]
    ds_read_b64_tr_b16 v[56:57], v16 offset:20480
    ds_read_b64_tr_b16 v[58:59], v17 offset:20480
    v_mfma_f32_32x32x16_bf16 v[144:159], v[160:163], v[176:179], v[144:159]
    s_waitcnt lgkmcnt(8)
    v_mfma_f32_32x32x16_bf16 v[80:95], v[180:183], v[188:191], v[80:95]
    ds_read_b128 v[60:63], v5 offset:16384
    ds_read_b64_tr_b16 v[68:69], v12 offset:25088
    v_mfma_f32_32x32x16_bf16 v[96:111], v[184:187], v[188:191], v[96:111]
    ds_read_b64_tr_b16 v[70:71], v12 offset:25376
    ds_read_b128 v[64:67], v9 offset:16384
    v_mfma_f32_32x32x16_bf16 v[112:127], v[180:183], v[192:195], v[112:127]
    ds_read_b64_tr_b16 v[72:73], v12 offset:25152
    ds_read_b64_tr_b16 v[74:75], v12 offset:25440
    v_mfma_f32_32x32x16_bf16 v[128:143], v[184:187], v[192:195], v[128:143]
    ds_read_b64_tr_b16 v[76:77], v18 offset:20480
    ds_read_b64_tr_b16 v[78:79], v19 offset:20480
    v_mfma_f32_32x32x16_bf16 v[144:159], v[180:183], v[196:199], v[144:159]
    s_waitcnt lgkmcnt(8)
    v_mfma_f32_32x32x16_bf16 v[80:95], v[40:43], v[48:51], v[80:95]
    ds_read_b128 v[160:163], v6 offset:16384
    ds_read_b64_tr_b16 v[168:169], v12 offset:29696
    v_mfma_f32_32x32x16_bf16 v[96:111], v[44:47], v[48:51], v[96:111]
    ds_read_b64_tr_b16 v[170:171], v12 offset:29984
    ds_read_b128 v[164:167], v10 offset:16384
    v_mfma_f32_32x32x16_bf16 v[112:127], v[40:43], v[52:55], v[112:127]
    ds_read_b64_tr_b16 v[172:173], v12 offset:29760
    ds_read_b64_tr_b16 v[174:175], v12 offset:30048
    v_mfma_f32_32x32x16_bf16 v[128:143], v[44:47], v[52:55], v[128:143]
    ds_read_b64_tr_b16 v[176:177], v20 offset:20480
    ds_read_b64_tr_b16 v[178:179], v21 offset:20480
    v_mfma_f32_32x32x16_bf16 v[144:159], v[40:43], v[56:59], v[144:159]
    s_waitcnt lgkmcnt(8)
    v_mfma_f32_32x32x16_bf16 v[80:95], v[60:63], v[68:71], v[80:95]
    ds_read_b128 v[180:183], v7 offset:16384
    ds_read_b64_tr_b16 v[188:189], v12 offset:34304
    v_mfma_f32_32x32x16_bf16 v[96:111], v[64:67], v[68:71], v[96:111]
    ds_read_b64_tr_b16 v[190:191], v12 offset:34592
    ds_read_b128 v[184:187], v11 offset:16384
    v_mfma_f32_32x32x16_bf16 v[112:127], v[60:63], v[72:75], v[112:127]
    ds_read_b64_tr_b16 v[192:193], v12 offset:34368
    ds_read_b64_tr_b16 v[194:195], v12 offset:34656
    v_mfma_f32_32x32x16_bf16 v[128:143], v[64:67], v[72:75], v[128:143]
    ds_read_b64_tr_b16 v[196:197], v22 offset:20480
    ds_read_b64_tr_b16 v[198:199], v23 offset:20480
    v_mfma_f32_32x32x16_bf16 v[144:159], v[60:63], v[76:79], v[144:159]
    s_waitcnt lgkmcnt(8)
    v_mfma_f32_32x32x16_bf16 v[80:95], v[160:163], v[168:171], v[80:95]
    s_barrier
    ds_read_b128 v[40:43], v4 offset:32768
    ds_read_b64_tr_b16 v[48:49], v13 offset:0
    v_mfma_f32_32x32x16_bf16 v[96:111], v[164:167], v[168:171], v[96:111]
    ds_read_b64_tr_b16 v[50:51], v13 offset:288
    ds_read_b128 v[44:47], v8 offset:32768
    v_mfma_f32_32x32x16_bf16 v[112:127], v[160:163], v[172:175], v[112:127]
    ds_read_b64_tr_b16 v[52:53], v13 offset:64
    ds_read_b64_tr_b16 v[54:55], v13 offset:352
    v_mfma_f32_32x32x16_bf16 v[128:143], v[164:167], v[172:175], v[128:143]
    ds_read_b64_tr_b16 v[56:57], v24 offset:0
    ds_read_b64_tr_b16 v[58:59], v25 offset:0
    v_mfma_f32_32x32x16_bf16 v[144:159], v[160:163], v[176:179], v[144:159]
    s_waitcnt lgkmcnt(8)
    v_mfma_f32_32x32x16_bf16 v[80:95], v[180:183], v[188:191], v[80:95]
    ds_read_b128 v[60:63], v5 offset:32768
    ds_read_b64_tr_b16 v[68:69], v13 offset:4608
    v_mfma_f32_32x32x16_bf16 v[96:111], v[184:187], v[188:191], v[96:111]
    ds_read_b64_tr_b16 v[70:71], v13 offset:4896
    ds_read_b128 v[64:67], v9 offset:32768
    v_mfma_f32_32x32x16_bf16 v[112:127], v[180:183], v[192:195], v[112:127]
    ds_read_b64_tr_b16 v[72:73], v13 offset:4672
    ds_read_b64_tr_b16 v[74:75], v13 offset:4960
    v_mfma_f32_32x32x16_bf16 v[128:143], v[184:187], v[192:195], v[128:143]
    ds_read_b64_tr_b16 v[76:77], v26 offset:0
    ds_read_b64_tr_b16 v[78:79], v27 offset:0
    v_mfma_f32_32x32x16_bf16 v[144:159], v[180:183], v[196:199], v[144:159]
    s_waitcnt lgkmcnt(8)
    v_mfma_f32_32x32x16_bf16 v[80:95], v[40:43], v[48:51], v[80:95]
    ds_read_b128 v[160:163], v6 offset:32768
    ds_read_b64_tr_b16 v[168:169], v13 offset:9216
    v_mfma_f32_32x32x16_bf16 v[96:111], v[44:47], v[48:51], v[96:111]
    ds_read_b64_tr_b16 v[170:171], v13 offset:9504
    ds_read_b128 v[164:167], v10 offset:32768
    v_mfma_f32_32x32x16_bf16 v[112:127], v[40:43], v[52:55], v[112:127]
    ds_read_b64_tr_b16 v[172:173], v13 offset:9280
    ds_read_b64_tr_b16 v[174:175], v13 offset:9568
    v_mfma_f32_32x32x16_bf16 v[128:143], v[44:47], v[52:55], v[128:143]
    ds_read_b64_tr_b16 v[176:177], v28 offset:0
    ds_read_b64_tr_b16 v[178:179], v29 offset:0
    v_mfma_f32_32x32x16_bf16 v[144:159], v[40:43], v[56:59], v[144:159]
    s_waitcnt lgkmcnt(8)
    v_mfma_f32_32x32x16_bf16 v[80:95], v[60:63], v[68:71], v[80:95]
    ds_read_b128 v[180:183], v7 offset:32768
    ds_read_b64_tr_b16 v[188:189], v13 offset:13824
    v_mfma_f32_32x32x16_bf16 v[96:111], v[64:67], v[68:71], v[96:111]
    ds_read_b64_tr_b16 v[190:191], v13 offset:14112
    ds_read_b128 v[184:187], v11 offset:32768
    v_mfma_f32_32x32x16_bf16 v[112:127], v[60:63], v[72:75], v[112:127]
    ds_read_b64_tr_b16 v[192:193], v13 offset:13888
    ds_read_b64_tr_b16 v[194:195], v13 offset:14176
    v_mfma_f32_32x32x16_bf16 v[128:143], v[64:67], v[72:75], v[128:143]
    ds_read_b64_tr_b16 v[196:197], v30 offset:0
    ds_read_b64_tr_b16 v[198:199], v31 offset:0
    v_mfma_f32_32x32x16_bf16 v[144:159], v[60:63], v[76:79], v[144:159]
    s_waitcnt lgkmcnt(8)
    v_mfma_f32_32x32x16_bf16 v[80:95], v[160:163], v[168:171], v[80:95]
    s_barrier
    ds_read_b128 v[40:43], v4 offset:49152
    ds_read_b64_tr_b16 v[48:49], v13 offset:20480
    v_mfma_f32_32x32x16_bf16 v[96:111], v[164:167], v[168:171], v[96:111]
    ds_read_b64_tr_b16 v[50:51], v13 offset:20768
    ds_read_b128 v[44:47], v8 offset:49152
    v_mfma_f32_32x32x16_bf16 v[112:127], v[160:163], v[172:175], v[112:127]
    ds_read_b64_tr_b16 v[52:53], v13 offset:20544
    ds_read_b64_tr_b16 v[54:55], v13 offset:20832
    v_mfma_f32_32x32x16_bf16 v[128:143], v[164:167], v[172:175], v[128:143]
    ds_read_b64_tr_b16 v[56:57], v24 offset:20480
    ds_read_b64_tr_b16 v[58:59], v25 offset:20480
    v_mfma_f32_32x32x16_bf16 v[144:159], v[160:163], v[176:179], v[144:159]
    s_waitcnt lgkmcnt(8)
    v_mfma_f32_32x32x16_bf16 v[80:95], v[180:183], v[188:191], v[80:95]
    ds_read_b128 v[60:63], v5 offset:49152
    ds_read_b64_tr_b16 v[68:69], v13 offset:25088
    v_mfma_f32_32x32x16_bf16 v[96:111], v[184:187], v[188:191], v[96:111]
    ds_read_b64_tr_b16 v[70:71], v13 offset:25376
    ds_read_b128 v[64:67], v9 offset:49152
    v_mfma_f32_32x32x16_bf16 v[112:127], v[180:183], v[192:195], v[112:127]
    ds_read_b64_tr_b16 v[72:73], v13 offset:25152
    ds_read_b64_tr_b16 v[74:75], v13 offset:25440
    v_mfma_f32_32x32x16_bf16 v[128:143], v[184:187], v[192:195], v[128:143]
    ds_read_b64_tr_b16 v[76:77], v26 offset:20480
    ds_read_b64_tr_b16 v[78:79], v27 offset:20480
    v_mfma_f32_32x32x16_bf16 v[144:159], v[180:183], v[196:199], v[144:159]
    s_waitcnt lgkmcnt(8)
    v_mfma_f32_32x32x16_bf16 v[80:95], v[40:43], v[48:51], v[80:95]
    ds_read_b128 v[160:163], v6 offset:49152
    ds_read_b64_tr_b16 v[168:169], v13 offset:29696
    v_mfma_f32_32x32x16_bf16 v[96:111], v[44:47], v[48:51], v[96:111]
    ds_read_b64_tr_b16 v[170:171], v13 offset:29984
    ds_read_b128 v[164:167], v10 offset:49152
    v_mfma_f32_32x32x16_bf16 v[112:127], v[40:43], v[52:55], v[112:127]
    ds_read_b64_tr_b16 v[172:173], v13 offset:29760
    ds_read_b64_tr_b16 v[174:175], v13 offset:30048
    v_mfma_f32_32x32x16_bf16 v[128:143], v[44:47], v[52:55], v[128:143]
    ds_read_b64_tr_b16 v[176:177], v28 offset:20480
    ds_read_b64_tr_b16 v[178:179], v29 offset:20480
    v_mfma_f32_32x32x16_bf16 v[144:159], v[40:43], v[56:59], v[144:159]
    s_waitcnt lgkmcnt(8)
    v_mfma_f32_32x32x16_bf16 v[80:95], v[60:63], v[68:71], v[80:95]
    ds_read_b128 v[180:183], v7 offset:49152
    ds_read_b64_tr_b16 v[188:189], v13 offset:34304
    v_mfma_f32_32x32x16_bf16 v[96:111], v[64:67], v[68:71], v[96:111]
    ds_read_b64_tr_b16 v[190:191], v13 offset:34592
    ds_read_b128 v[184:187], v11 offset:49152
    v_mfma_f32_32x32x16_bf16 v[112:127], v[60:63], v[72:75], v[112:127]
    ds_read_b64_tr_b16 v[192:193], v13 offset:34368
    ds_read_b64_tr_b16 v[194:195], v13 offset:34656
    v_mfma_f32_32x32x16_bf16 v[128:143], v[64:67], v[72:75], v[128:143]
    ds_read_b64_tr_b16 v[196:197], v30 offset:20480
    ds_read_b64_tr_b16 v[198:199], v31 offset:20480
    v_mfma_f32_32x32x16_bf16 v[144:159], v[60:63], v[76:79], v[144:159]
    s_waitcnt lgkmcnt(8)
    v_mfma_f32_32x32x16_bf16 v[80:95], v[160:163], v[168:171], v[80:95]
    s_barrier
    ds_read_b128 v[40:43], v4 offset:0
    ds_read_b64_tr_b16 v[48:49], v12 offset:0
    v_mfma_f32_32x32x16_bf16 v[96:111], v[164:167], v[168:171], v[96:111]
    ds_read_b64_tr_b16 v[50:51], v12 offset:288
    ds_read_b128 v[44:47], v8 offset:0
    v_mfma_f32_32x32x16_bf16 v[112:127], v[160:163], v[172:175], v[112:127]
    ds_read_b64_tr_b16 v[52:53], v12 offset:64
    ds_read_b64_tr_b16 v[54:55], v12 offset:352
    v_mfma_f32_32x32x16_bf16 v[128:143], v[164:167], v[172:175], v[128:143]
    ds_read_b64_tr_b16 v[56:57], v16 offset:0
    ds_read_b64_tr_b16 v[58:59], v17 offset:0
    v_mfma_f32_32x32x16_bf16 v[144:159], v[160:163], v[176:179], v[144:159]
    s_waitcnt lgkmcnt(8)
    v_mfma_f32_32x32x16_bf16 v[80:95], v[180:183], v[188:191], v[80:95]
    ds_read_b128 v[60:63], v5 offset:0
    ds_read_b64_tr_b16 v[68:69], v12 offset:4608
    v_mfma_f32_32x32x16_bf16 v[96:111], v[184:187], v[188:191], v[96:111]
    ds_read_b64_tr_b16 v[70:71], v12 offset:4896
    ds_read_b128 v[64:67], v9 offset:0
    v_mfma_f32_32x32x16_bf16 v[112:127], v[180:183], v[192:195], v[112:127]
    ds_read_b64_tr_b16 v[72:73], v12 offset:4672
    ds_read_b64_tr_b16 v[74:75], v12 offset:4960
    v_mfma_f32_32x32x16_bf16 v[128:143], v[184:187], v[192:195], v[128:143]
    ds_read_b64_tr_b16 v[76:77], v18 offset:0
    ds_read_b64_tr_b16 v[78:79], v19 offset:0
    v_mfma_f32_32x32x16_bf16 v[144:159], v[180:183], v[196:199], v[144:159]
    s_waitcnt lgkmcnt(8)
    v_mfma_f32_32x32x16_bf16 v[80:95], v[40:43], v[48:51], v[80:95]
    ds_read_b128 v[160:163], v6 offset:0
    ds_read_b64_tr_b16 v[168:169], v12 offset:9216
    v_mfma_f32_32x32x16_bf16 v[96:111], v[44:47], v[48:51], v[96:111]
    ds_read_b64_tr_b16 v[170:171], v12 offset:9504
    ds_read_b128 v[164:167], v10 offset:0
    v_mfma_f32_32x32x16_bf16 v[112:127], v[40:43], v[52:55], v[112:127]
    ds_read_b64_tr_b16 v[172:173], v12 offset:9280
    ds_read_b64_tr_b16 v[174:175], v12 offset:9568
    v_mfma_f32_32x32x16_bf16 v[128:143], v[44:47], v[52:55], v[128:143]
    ds_read_b64_tr_b16 v[176:177], v20 offset:0
    ds_read_b64_tr_b16 v[178:179], v21 offset:0
    v_mfma_f32_32x32x16_bf16 v[144:159], v[40:43], v[56:59], v[144:159]
    s_waitcnt lgkmcnt(8)
    v_mfma_f32_32x32x16_bf16 v[80:95], v[60:63], v[68:71], v[80:95]
    ds_read_b128 v[180:183], v7 offset:0
    ds_read_b64_tr_b16 v[188:189], v12 offset:13824
    v_mfma_f32_32x32x16_bf16 v[96:111], v[64:67], v[68:71], v[96:111]
    ds_read_b64_tr_b16 v[190:191], v12 offset:14112
    ds_read_b128 v[184:187], v11 offset:0
    v_mfma_f32_32x32x16_bf16 v[112:127], v[60:63], v[72:75], v[112:127]
    ds_read_b64_tr_b16 v[192:193], v12 offset:13888
    ds_read_b64_tr_b16 v[194:195], v12 offset:14176
    v_mfma_f32_32x32x16_bf16 v[128:143], v[64:67], v[72:75], v[128:143]
    ds_read_b64_tr_b16 v[196:197], v22 offset:0
    ds_read_b64_tr_b16 v[198:199], v23 offset:0
    v_mfma_f32_32x32x16_bf16 v[144:159], v[60:63], v[76:79], v[144:159]
    s_waitcnt lgkmcnt(8)
    v_mfma_f32_32x32x16_bf16 v[80:95], v[160:163], v[168:171], v[80:95]
    s_barrier
    ds_read_b128 v[40:43], v4 offset:16384
    ds_read_b64_tr_b16 v[48:49], v12 offset:20480
    v_mfma_f32_32x32x16_bf16 v[96:111], v[164:167], v[168:171], v[96:111]
    ds_read_b64_tr_b16 v[50:51], v12 offset:20768
    ds_read_b128 v[44:47], v8 offset:16384
    v_mfma_f32_32x32x16_bf16 v[112:127], v[160:163], v[172:175], v[112:127]
    ds_read_b64_tr_b16 v[52:53], v12 offset:20544
    ds_read_b64_tr_b16 v[54:55], v12 offset:20832
    v_mfma_f32_32x32x16_bf16 v[128:143], v[164:167], v[172:175], v[128:143]
    ds_read_b64_tr_b16 v[56:57], v16 offset:20480
    ds_read_b64_tr_b16 v[58:59], v17 offset:20480
    v_mfma_f32_32x32x16_bf16 v[144:159], v[160:163], v[176:179], v[144:159]
    s_waitcnt lgkmcnt(8)
    v_mfma_f32_32x32x16_bf16 v[80:95], v[180:183], v[188:191], v[80:95]
    ds_read_b128 v[60:63], v5 offset:16384
    ds_read_b64_tr_b16 v[68:69], v12 offset:25088
    v_mfma_f32_32x32x16_bf16 v[96:111], v[184:187], v[188:191], v[96:111]
    ds_read_b64_tr_b16 v[70:71], v12 offset:25376
    ds_read_b128 v[64:67], v9 offset:16384
    v_mfma_f32_32x32x16_bf16 v[112:127], v[180:183], v[192:195], v[112:127]
    ds_read_b64_tr_b16 v[72:73], v12 offset:25152
    ds_read_b64_tr_b16 v[74:75], v12 offset:25440
    v_mfma_f32_32x32x16_bf16 v[128:143], v[184:187], v[192:195], v[128:143]
    ds_read_b64_tr_b16 v[76:77], v18 offset:20480
    ds_read_b64_tr_b16 v[78:79], v19 offset:20480
    v_mfma_f32_32x32x16_bf16 v[144:159], v[180:183], v[196:199], v[144:159]
    s_waitcnt lgkmcnt(8)
    v_mfma_f32_32x32x16_bf16 v[80:95], v[40:43], v[48:51], v[80:95]
    ds_read_b128 v[160:163], v6 offset:16384
    ds_read_b64_tr_b16 v[168:169], v12 offset:29696
    v_mfma_f32_32x32x16_bf16 v[96:111], v[44:47], v[48:51], v[96:111]
    ds_read_b64_tr_b16 v[170:171], v12 offset:29984
    ds_read_b128 v[164:167], v10 offset:16384
    v_mfma_f32_32x32x16_bf16 v[112:127], v[40:43], v[52:55], v[112:127]
    ds_read_b64_tr_b16 v[172:173], v12 offset:29760
    ds_read_b64_tr_b16 v[174:175], v12 offset:30048
    v_mfma_f32_32x32x16_bf16 v[128:143], v[44:47], v[52:55], v[128:143]
    ds_read_b64_tr_b16 v[176:177], v20 offset:20480
    ds_read_b64_tr_b16 v[178:179], v21 offset:20480
    v_mfma_f32_32x32x16_bf16 v[144:159], v[40:43], v[56:59], v[144:159]
    s_waitcnt lgkmcnt(8)
    v_mfma_f32_32x32x16_bf16 v[80:95], v[60:63], v[68:71], v[80:95]
    ds_read_b128 v[180:183], v7 offset:16384
    ds_read_b64_tr_b16 v[188:189], v12 offset:34304
    v_mfma_f32_32x32x16_bf16 v[96:111], v[64:67], v[68:71], v[96:111]
    ds_read_b64_tr_b16 v[190:191], v12 offset:34592
    ds_read_b128 v[184:187], v11 offset:16384
    v_mfma_f32_32x32x16_bf16 v[112:127], v[60:63], v[72:75], v[112:127]
    ds_read_b64_tr_b16 v[192:193], v12 offset:34368
    ds_read_b64_tr_b16 v[194:195], v12 offset:34656
    v_mfma_f32_32x32x16_bf16 v[128:143], v[64:67], v[72:75], v[128:143]
    ds_read_b64_tr_b16 v[196:197], v22 offset:20480
    ds_read_b64_tr_b16 v[198:199], v23 offset:20480
    v_mfma_f32_32x32x16_bf16 v[144:159], v[60:63], v[76:79], v[144:159]
    s_waitcnt lgkmcnt(8)
    v_mfma_f32_32x32x16_bf16 v[80:95], v[160:163], v[168:171], v[80:95]
    s_barrier
    ds_read_b128 v[40:43], v4 offset:32768
    ds_read_b64_tr_b16 v[48:49], v13 offset:0
    v_mfma_f32_32x32x16_bf16 v[96:111], v[164:167], v[168:171], v[96:111]
    ds_read_b64_tr_b16 v[50:51], v13 offset:288
    ds_read_b128 v[44:47], v8 offset:32768
    v_mfma_f32_32x32x16_bf16 v[112:127], v[160:163], v[172:175], v[112:127]
    ds_read_b64_tr_b16 v[52:53], v13 offset:64
    ds_read_b64_tr_b16 v[54:55], v13 offset:352
    v_mfma_f32_32x32x16_bf16 v[128:143], v[164:167], v[172:175], v[128:143]
    ds_read_b64_tr_b16 v[56:57], v24 offset:0
    ds_read_b64_tr_b16 v[58:59], v25 offset:0
    v_mfma_f32_32x32x16_bf16 v[144:159], v[160:163], v[176:179], v[144:159]
    s_waitcnt lgkmcnt(8)
    v_mfma_f32_32x32x16_bf16 v[80:95], v[180:183], v[188:191], v[80:95]
    ds_read_b128 v[60:63], v5 offset:32768
    ds_read_b64_tr_b16 v[68:69], v13 offset:4608
    v_mfma_f32_32x32x16_bf16 v[96:111], v[184:187], v[188:191], v[96:111]
    ds_read_b64_tr_b16 v[70:71], v13 offset:4896
    ds_read_b128 v[64:67], v9 offset:32768
    v_mfma_f32_32x32x16_bf16 v[112:127], v[180:183], v[192:195], v[112:127]
    ds_read_b64_tr_b16 v[72:73], v13 offset:4672
    ds_read_b64_tr_b16 v[74:75], v13 offset:4960
    v_mfma_f32_32x32x16_bf16 v[128:143], v[184:187], v[192:195], v[128:143]
    ds_read_b64_tr_b16 v[76:77], v26 offset:0
    ds_read_b64_tr_b16 v[78:79], v27 offset:0
    v_mfma_f32_32x32x16_bf16 v[144:159], v[180:183], v[196:199], v[144:159]
    s_waitcnt lgkmcnt(8)
    v_mfma_f32_32x32x16_bf16 v[80:95], v[40:43], v[48:51], v[80:95]
    ds_read_b128 v[160:163], v6 offset:32768
    ds_read_b64_tr_b16 v[168:169], v13 offset:9216
    v_mfma_f32_32x32x16_bf16 v[96:111], v[44:47], v[48:51], v[96:111]
    ds_read_b64_tr_b16 v[170:171], v13 offset:9504
    ds_read_b128 v[164:167], v10 offset:32768
    v_mfma_f32_32x32x16_bf16 v[112:127], v[40:43], v[52:55], v[112:127]
    ds_read_b64_tr_b16 v[172:173], v13 offset:9280
    ds_read_b64_tr_b16 v[174:175], v13 offset:9568
    v_mfma_f32_32x32x16_bf16 v[128:143], v[44:47], v[52:55], v[128:143]
    ds_read_b64_tr_b16 v[176:177], v28 offset:0
    ds_read_b64_tr_b16 v[178:179], v29 offset:0
    v_mfma_f32_32x32x16_bf16 v[144:159], v[40:43], v[56:59], v[144:159]
    s_waitcnt lgkmcnt(8)
    v_mfma_f32_32x32x16_bf16 v[80:95], v[60:63], v[68:71], v[80:95]
    ds_read_b128 v[180:183], v7 offset:32768
    ds_read_b64_tr_b16 v[188:189], v13 offset:13824
    v_mfma_f32_32x32x16_bf16 v[96:111], v[64:67], v[68:71], v[96:111]
    ds_read_b64_tr_b16 v[190:191], v13 offset:14112
    ds_read_b128 v[184:187], v11 offset:32768
    v_mfma_f32_32x32x16_bf16 v[112:127], v[60:63], v[72:75], v[112:127]
    ds_read_b64_tr_b16 v[192:193], v13 offset:13888
    ds_read_b64_tr_b16 v[194:195], v13 offset:14176
    v_mfma_f32_32x32x16_bf16 v[128:143], v[64:67], v[72:75], v[128:143]
    ds_read_b64_tr_b16 v[196:197], v30 offset:0
    ds_read_b64_tr_b16 v[198:199], v31 offset:0
    v_mfma_f32_32x32x16_bf16 v[144:159], v[60:63], v[76:79], v[144:159]
    s_waitcnt lgkmcnt(8)
    v_mfma_f32_32x32x16_bf16 v[80:95], v[160:163], v[168:171], v[80:95]
    s_barrier
    ds_read_b128 v[40:43], v4 offset:49152
    ds_read_b64_tr_b16 v[48:49], v13 offset:20480
    v_mfma_f32_32x32x16_bf16 v[96:111], v[164:167], v[168:171], v[96:111]
    ds_read_b64_tr_b16 v[50:51], v13 offset:20768
    ds_read_b128 v[44:47], v8 offset:49152
    v_mfma_f32_32x32x16_bf16 v[112:127], v[160:163], v[172:175], v[112:127]
    ds_read_b64_tr_b16 v[52:53], v13 offset:20544
    ds_read_b64_tr_b16 v[54:55], v13 offset:20832
    v_mfma_f32_32x32x16_bf16 v[128:143], v[164:167], v[172:175], v[128:143]
    ds_read_b64_tr_b16 v[56:57], v24 offset:20480
    ds_read_b64_tr_b16 v[58:59], v25 offset:20480
    v_mfma_f32_32x32x16_bf16 v[144:159], v[160:163], v[176:179], v[144:159]
    s_waitcnt lgkmcnt(8)
    v_mfma_f32_32x32x16_bf16 v[80:95], v[180:183], v[188:191], v[80:95]
    ds_read_b128 v[60:63], v5 offset:49152
    ds_read_b64_tr_b16 v[68:69], v13 offset:25088
    v_mfma_f32_32x32x16_bf16 v[96:111], v[184:187], v[188:191], v[96:111]
    ds_read_b64_tr_b16 v[70:71], v13 offset:25376
    ds_read_b128 v[64:67], v9 offset:49152
    v_mfma_f32_32x32x16_bf16 v[112:127], v[180:183], v[192:195], v[112:127]
    ds_read_b64_tr_b16 v[72:73], v13 offset:25152
    ds_read_b64_tr_b16 v[74:75], v13 offset:25440
    v_mfma_f32_32x32x16_bf16 v[128:143], v[184:187], v[192:195], v[128:143]
    ds_read_b64_tr_b16 v[76:77], v26 offset:20480
    ds_read_b64_tr_b16 v[78:79], v27 offset:20480
    v_mfma_f32_32x32x16_bf16 v[144:159], v[180:183], v[196:199], v[144:159]
    s_waitcnt lgkmcnt(8)
    v_mfma_f32_32x32x16_bf16 v[80:95], v[40:43], v[48:51], v[80:95]
    ds_read_b128 v[160:163], v6 offset:49152
    ds_read_b64_tr_b16 v[168:169], v13 offset:29696
    v_mfma_f32_32x32x16_bf16 v[96:111], v[44:47], v[48:51], v[96:111]
    ds_read_b64_tr_b16 v[170:171], v13 offset:29984
    ds_read_b128 v[164:167], v10 offset:49152
    v_mfma_f32_32x32x16_bf16 v[112:127], v[40:43], v[52:55], v[112:127]
    ds_read_b64_tr_b16 v[172:173], v13 offset:29760
    ds_read_b64_tr_b16 v[174:175], v13 offset:30048
    v_mfma_f32_32x32x16_bf16 v[128:143], v[44:47], v[52:55], v[128:143]
    ds_read_b64_tr_b16 v[176:177], v28 offset:20480
    ds_read_b64_tr_b16 v[178:179], v29 offset:20480
    v_mfma_f32_32x32x16_bf16 v[144:159], v[40:43], v[56:59], v[144:159]
    s_waitcnt lgkmcnt(8)
    v_mfma_f32_32x32x16_bf16 v[80:95], v[60:63], v[68:71], v[80:95]
    ds_read_b128 v[180:183], v7 offset:49152
    ds_read_b64_tr_b16 v[188:189], v13 offset:34304
    v_mfma_f32_32x32x16_bf16 v[96:111], v[64:67], v[68:71], v[96:111]
    ds_read_b64_tr_b16 v[190:191], v13 offset:34592
    ds_read_b128 v[184:187], v11 offset:49152
    v_mfma_f32_32x32x16_bf16 v[112:127], v[60:63], v[72:75], v[112:127]
    ds_read_b64_tr_b16 v[192:193], v13 offset:34368
    ds_read_b64_tr_b16 v[194:195], v13 offset:34656
    v_mfma_f32_32x32x16_bf16 v[128:143], v[64:67], v[72:75], v[128:143]
    ds_read_b64_tr_b16 v[196:197], v30 offset:20480
    ds_read_b64_tr_b16 v[198:199], v31 offset:20480
    v_mfma_f32_32x32x16_bf16 v[144:159], v[60:63], v[76:79], v[144:159]
    s_waitcnt lgkmcnt(8)
    v_mfma_f32_32x32x16_bf16 v[80:95], v[160:163], v[168:171], v[80:95]
    s_barrier
    ds_read_b128 v[40:43], v4 offset:0
    ds_read_b64_tr_b16 v[48:49], v12 offset:0
    v_mfma_f32_32x32x16_bf16 v[96:111], v[164:167], v[168:171], v[96:111]
    ds_read_b64_tr_b16 v[50:51], v12 offset:288
    ds_read_b128 v[44:47], v8 offset:0
    v_mfma_f32_32x32x16_bf16 v[112:127], v[160:163], v[172:175], v[112:127]
    ds_read_b64_tr_b16 v[52:53], v12 offset:64
    ds_read_b64_tr_b16 v[54:55], v12 offset:352
    v_mfma_f32_32x32x16_bf16 v[128:143], v[164:167], v[172:175], v[128:143]
    ds_read_b64_tr_b16 v[56:57], v16 offset:0
    ds_read_b64_tr_b16 v[58:59], v17 offset:0
    v_mfma_f32_32x32x16_bf16 v[144:159], v[160:163], v[176:179], v[144:159]
    s_waitcnt lgkmcnt(8)
    v_mfma_f32_32x32x16_bf16 v[80:95], v[180:183], v[188:191], v[80:95]
    ds_read_b128 v[60:63], v5 offset:0
    ds_read_b64_tr_b16 v[68:69], v12 offset:4608
    v_mfma_f32_32x32x16_bf16 v[96:111], v[184:187], v[188:191], v[96:111]
    ds_read_b64_tr_b16 v[70:71], v12 offset:4896
    ds_read_b128 v[64:67], v9 offset:0
    v_mfma_f32_32x32x16_bf16 v[112:127], v[180:183], v[192:195], v[112:127]
    ds_read_b64_tr_b16 v[72:73], v12 offset:4672
    ds_read_b64_tr_b16 v[74:75], v12 offset:4960
    v_mfma_f32_32x32x16_bf16 v[128:143], v[184:187], v[192:195], v[128:143]
    ds_read_b64_tr_b16 v[76:77], v18 offset:0
    ds_read_b64_tr_b16 v[78:79], v19 offset:0
    v_mfma_f32_32x32x16_bf16 v[144:159], v[180:183], v[196:199], v[144:159]
    s_waitcnt lgkmcnt(7)
    v_mfma_f32_32x32x16_bf16 v[80:95], v[40:43], v[48:51], v[80:95]
    ds_read_b128 v[160:163], v6 offset:0
    ds_read_b64_tr_b16 v[168:169], v12 offset:9216
    ds_read_b64_tr_b16 v[170:171], v12 offset:9504
    ds_read_b128 v[164:167], v10 offset:0
    ds_read_b64_tr_b16 v[172:173], v12 offset:9280
    ds_read_b64_tr_b16 v[174:175], v12 offset:9568
    ds_read_b64_tr_b16 v[176:177], v20 offset:0
    ds_read_b64_tr_b16 v[178:179], v21 offset:0
    v_mfma_f32_32x32x16_bf16 v[96:111], v[44:47], v[48:51], v[96:111]
    s_waitcnt lgkmcnt(7)
    v_mfma_f32_32x32x16_bf16 v[80:95], v[60:63], v[68:71], v[80:95]
    ds_read_b128 v[180:183], v7 offset:0
    ds_read_b64_tr_b16 v[188:189], v12 offset:13824
    ds_read_b64_tr_b16 v[190:191], v12 offset:14112
    ds_read_b128 v[184:187], v11 offset:0
    ds_read_b64_tr_b16 v[192:193], v12 offset:13888
    ds_read_b64_tr_b16 v[194:195], v12 offset:14176
    ds_read_b64_tr_b16 v[196:197], v22 offset:0
    ds_read_b64_tr_b16 v[198:199], v23 offset:0
    v_mfma_f32_32x32x16_bf16 v[96:111], v[64:67], v[68:71], v[96:111]
    s_waitcnt lgkmcnt(8)
    v_mfma_f32_32x32x16_bf16 v[80:95], v[160:163], v[168:171], v[80:95]
    v_mfma_f32_32x32x16_bf16 v[112:127], v[40:43], v[52:55], v[112:127]
    s_waitcnt lgkmcnt(0)
    v_mfma_f32_32x32x16_bf16 v[80:95], v[180:183], v[188:191], v[80:95]
    v_mfma_f32_32x32x16_bf16 v[96:111], v[164:167], v[168:171], v[96:111]
    v_mfma_f32_32x32x16_bf16 v[96:111], v[184:187], v[188:191], v[96:111]
    s_nop 9
    v_cvt_pk_bf16_f32 v200, v80, v81
    v_cvt_pk_bf16_f32 v201, v82, v83
    v_cvt_pk_bf16_f32 v202, v84, v85
    v_cvt_pk_bf16_f32 v203, v86, v87
    v_mfma_f32_32x32x16_bf16 v[112:127], v[60:63], v[72:75], v[112:127]
    s_add_u32 s50, s58, 0
    buffer_store_dwordx4 v[200:203], v32, s[24:27], s50 offen offset:0 sc1
    v_cvt_pk_bf16_f32 v204, v88, v89
    v_cvt_pk_bf16_f32 v205, v90, v91
    v_cvt_pk_bf16_f32 v206, v92, v93
    v_cvt_pk_bf16_f32 v207, v94, v95
    s_add_u32 s50, s58, 19712
    buffer_store_dwordx4 v[204:207], v32, s[24:27], s50 offen offset:0 sc1
    v_mfma_f32_32x32x16_bf16 v[112:127], v[160:163], v[172:175], v[112:127]
    v_cvt_pk_bf16_f32 v208, v96, v97
    v_cvt_pk_bf16_f32 v209, v98, v99
    v_cvt_pk_bf16_f32 v210, v100, v101
    v_cvt_pk_bf16_f32 v211, v102, v103
    v_mfma_f32_32x32x16_bf16 v[112:127], v[180:183], v[192:195], v[112:127]
    s_add_u32 s50, s59, 0
    buffer_store_dwordx4 v[208:211], v32, s[24:27], s50 offen offset:0 sc1
    v_cvt_pk_bf16_f32 v212, v104, v105
    v_cvt_pk_bf16_f32 v213, v106, v107
    v_mfma_f32_32x32x16_bf16 v[128:143], v[44:47], v[52:55], v[128:143]
    v_cvt_pk_bf16_f32 v214, v108, v109
    v_cvt_pk_bf16_f32 v215, v110, v111
    s_add_u32 s50, s59, 19712
    buffer_store_dwordx4 v[212:215], v32, s[24:27], s50 offen offset:0 sc1
    v_mfma_f32_32x32x16_bf16 v[128:143], v[64:67], v[72:75], v[128:143]
    s_nop 1
    v_cvt_pk_bf16_f32 v216, v112, v113
    v_cvt_pk_bf16_f32 v217, v114, v115
    v_cvt_pk_bf16_f32 v218, v116, v117
    v_cvt_pk_bf16_f32 v219, v118, v119
    v_mfma_f32_32x32x16_bf16 v[128:143], v[164:167], v[172:175], v[128:143]
    s_add_u32 s50, s58, 0
    buffer_store_dwordx4 v[216:219], v32, s[24:27], s50 offen offset:512 sc1
    v_cvt_pk_bf16_f32 v220, v120, v121
    v_cvt_pk_bf16_f32 v221, v122, v123
    v_mfma_f32_32x32x16_bf16 v[128:143], v[184:187], v[192:195], v[128:143]
    v_cvt_pk_bf16_f32 v222, v124, v125
    v_cvt_pk_bf16_f32 v223, v126, v127
    s_add_u32 s50, s58, 19712
    buffer_store_dwordx4 v[220:223], v32, s[24:27], s50 offen offset:512 sc1
    v_mfma_f32_32x32x16_bf16 v[144:159], v[40:43], v[56:59], v[144:159]
    v_mfma_f32_32x32x16_bf16 v[144:159], v[60:63], v[76:79], v[144:159]
    s_nop 5
    v_cvt_pk_bf16_f32 v224, v128, v129
    v_cvt_pk_bf16_f32 v225, v130, v131
    v_cvt_pk_bf16_f32 v226, v132, v133
    v_cvt_pk_bf16_f32 v227, v134, v135
    v_mfma_f32_32x32x16_bf16 v[144:159], v[160:163], v[176:179], v[144:159]
    s_add_u32 s50, s59, 0
    buffer_store_dwordx4 v[224:227], v32, s[24:27], s50 offen offset:512 sc1
    v_cvt_pk_bf16_f32 v228, v136, v137
    v_cvt_pk_bf16_f32 v229, v138, v139
    v_mfma_f32_32x32x16_bf16 v[144:159], v[180:183], v[196:199], v[144:159]
    v_cvt_pk_bf16_f32 v230, v140, v141
    v_cvt_pk_bf16_f32 v231, v142, v143
    s_add_u32 s50, s59, 19712
    buffer_store_dwordx4 v[228:231], v32, s[24:27], s50 offen offset:512 sc1
    s_nop 11
    v_cvt_pk_bf16_f32 v232, v144, v145
    v_cvt_pk_bf16_f32 v233, v146, v147
    v_cvt_pk_bf16_f32 v234, v148, v149
    v_cvt_pk_bf16_f32 v235, v150, v151
    s_add_u32 s50, s58, 0
    buffer_store_dwordx4 v[232:235], v33, s[24:27], s50 offen offset:0 sc1
    v_cvt_pk_bf16_f32 v236, v152, v153
    v_cvt_pk_bf16_f32 v237, v154, v155
    v_cvt_pk_bf16_f32 v238, v156, v157
    v_cvt_pk_bf16_f32 v239, v158, v159
    s_add_u32 s50, s58, 19712
    buffer_store_dwordx4 v[236:239], v33, s[24:27], s50 offen offset:0 sc1
L1_end:
    s_endpgm
.globl attn_kernel
.p2align 8
.type attn_kernel,@function
attn_kernel:
    s_cmp_ge_u32 s2, 256
    s_cbranch_scc1 L2_end
    s_load_dwordx2 s[4:5], s[0:1], 88
    s_load_dwordx2 s[6:7], s[0:1], 72
    s_load_dwordx2 s[8:9], s[0:1], 16
    s_load_dwordx2 s[10:11], s[0:1], 56
    v_lshrrev_b32 v2, 6, v0
    v_and_b32 v1, 63, v0
    s_and_b32 s42, s2, 7
    v_readfirstlane_b32 s35, v2
    s_lshr_b32 s43, s2, 3
    s_lshl_b32 s30, s42, 2
    s_and_b32 s44, s43, 3
    s_add_u32 s30, s30, s44
    s_lshr_b32 s31, s43, 2
    s_lshr_b32 s32, s43, 4
    s_lshr_b32 s33, s43, 2
    s_and_b32 s33, s33, 3
    s_lshl_b32 s42, s42, 2
    s_add_u32 s33, s33, s42
    s_and_b32 s34, s43, 3
    s_and_b32 s44, s33, 1
    s_add_u32 s44, s44, 32
    s_cmp_eq_u32 s32, 0
    s_cselect_b32 s44, s33, s44
    s_mul_i32 s36, s44, 73728
    s_mul_i32 s62, s33, 288
    s_cselect_b32 s62, s62, 9216
    s_cselect_b32 s63, 0, 224
    v_lshlrev_b32 v2, 4, v1
    s_cmp_eq_u32 s35, 8
    s_cbranch_scc1 L2_loader
    s_lshl_b32 s44, s32, 5
    s_add_u32 s44, s44, s33
    s_mul_i32 s37, s44, 73728
    s_lshl_b32 s38, s34, 4
    s_lshl_b32 s44, s35, 1
    s_add_u32 s38, s38, s44
    s_lshr_b32 s44, s38, 3
    s_mul_i32 s44, s44, 9216
    s_add_u32 s37, s37, s44
    s_add_u32 s37, s37, 2506752
    s_and_b32 s44, s38, 7
    s_lshl_b32 s45, s44, 10
    s_add_u32 s45, s45, s37
    s_lshl_b32 s46, s44, 7
    s_add_u32 s46, s46, s37
    s_add_u32 s46, s46, 8192
    s_add_u32 s47, s36, 8192
    s_lshl_b32 s44, s35, 10
    s_add_u32 s48, s36, s44
    s_mov_b32 s49, 7225344
    v_lshlrev_b32 v3, 2, v1
    v_mov_b32 v52, v0

    v_mul_u32_u24 v54, 3450, v52
    v_lshrrev_b32 v54, 16, v54
    v_mul_u32_u24 v55, 19, v54
    v_sub_u32 v55, v52, v55
    v_mul_u32_u24 v54, 9856, v54
    v_cmp_lt_u32 vcc, 15, v55
    v_lshl_add_u32 v98, v55, 4, s62
    v_add_u32 v52, s63, v98
    v_cndmask_b32 v98, v98, v52, vcc
    v_cmp_eq_u32 vcc, 18, v55
    v_mov_b32 v52, 9728
    s_nop 0
    v_cndmask_b32 v98, v98, v52, vcc
    v_add_u32 v98, v98, v54

    v_and_b32 v6, 31, v1
    v_and_b32 v7, 0x13, v6
    v_and_b32 v52, 4, v6
    v_lshl_or_b32 v7, v52, 1, v7
    v_and_b32 v52, 8, v6
    v_lshrrev_b32 v52, 1, v52
    v_or_b32 v7, v7, v52
    v_cmp_gt_u32 vcc, 19, v6
    v_mov_b32 v52, 32768
    v_mov_b32 v53, 18
    v_cndmask_b32 v7, v52, v7, vcc
    v_cmp_eq_u32 vcc, 28, v6
    s_nop 1
    v_cndmask_b32 v7, v7, v53, vcc
    v_cmp_le_u32 vcc, 32, v6
    s_nop 1
    v_cndmask_b32 v7, v7, v53, vcc
    v_lshrrev_b32 v52, 5, v1
    v_mul_u32_u24 v52, 304, v52
    v_lshl_add_u32 v4, v7, 4, v52

    s_mov_b32 s22, 15974528
    s_mov_b32 s23, 0x00020000
    s_mov_b32 m0, s44
    s_waitcnt lgkmcnt(0)
    s_mov_b32 s20, s4
    s_mov_b32 s21, s5
    buffer_load_dword v16, v3, s[20:23], s46 offen
    buffer_load_dword v24, v3, s[20:23], s47 offen
    buffer_load_dwordx4 v[28:31], v2, s[20:23], s36 offen
    buffer_load_dwordx4 v[8:11], v2, s[20:23], s45 offen
    buffer_load_dwordx4 v[12:15], v2, s[20:23], s45 offen offset:1024

    buffer_load_dwordx4 v2, s[20:23], s48 offen lds
    s_add_u32 m0, s44, 9216
    s_nop 0
    buffer_load_dwordx4 v98, s[20:23], s49 offen lds
    v_lshlrev_b32 v54, 2, v0
    v_add_u32 v54, 161280, v54
    ds_write_b32 v54, v98

    v_mov_b32 v5, 0xdddddddd
    v_mov_b32 v25, 0x3f803f80
    v_mov_b32 v27, 0x3f803f80
    v_mov_b32 v17, 0
    v_mov_b32 v6, 163584
    v_mov_b32 v7, 1

    s_lshr_b32 s39, s35, 1
    s_and_b32 s37, s35, 1
    s_lshl_b32 s49, s30, 6
    s_lshl_b32 s52, s37, 5
    s_add_u32 s49, s49, s52
    s_lshl_b32 s52, s39, 3
    s_add_u32 s53, s49, s52
    s_mov_b32 s54, 15794176
    v_lshrrev_b32 v52, 3, v1
    v_and_b32 v53, 7, v1
    v_add_u32 v54, s53, v52
    v_and_b32 v97, 31, v1
    v_add_u32 v55, s49, v97
    v_lshlrev_b32 v56, 3, v54
    v_lshlrev_b32 v58, 3, v55
    buffer_load_dwordx2 v[56:57], v56, s[20:23], s54 offen
    buffer_load_dwordx2 v[58:59], v58, s[20:23], s54 offen
    s_movk_i32 s54, 1152
    v_mul_lo_u32 v54, v54, s54
    v_lshl_add_u32 v62, v53, 4, v54
    v_mul_lo_u32 v55, v55, s54
    v_mov_b32 v96, 0x7ff00000
    v_cmp_gt_u32 vcc, 32, v1
    v_add_u32 v52, s52, v52
    s_mul_i32 s54, s37, 10496
    v_cndmask_b32 v63, v96, v55, vcc
    v_bfe_u32 v54, v1, 1, 2
    v_mul_u32_u24 v54, 2368, v54
    v_and_b32 v55, 1, v1
    v_mul_u32_u24 v55, 544, v55
    v_lshl_add_u32 v54, v52, 4, v54
    v_add3_u32 v60, v54, v55, s54
    v_and_b32 v54, 15, v97
    v_and_b32 v55, 16, v97
    v_lshl_add_u32 v54, v55, 1, v54
    v_lshl_add_u32 v54, v54, 4, s54
    v_add_u32 v61, 9472, v54
    v_and_b32 v52, 31, v1
    v_lshrrev_b32 v53, 5, v1
    s_mul_i32 s19, s39, 36864
    s_add_u32 s55, s19, s54
    v_mul_u32_u24 v54, 544, v53
    v_lshl_add_u32 v54, v52, 4, v54
    v_add_u32 v23, s55, v54
    v_lshlrev_b32 v54, 2, v52
    v_lshl_add_u32 v20, v53, 13, v54
    v_lshl_add_u32 v21, v53, 9, v54
    v_and_b32 v54, 0x13, v52
    v_and_b32 v55, 4, v52
    v_lshl_or_b32 v54, v55, 1, v54
    v_and_b32 v55, 8, v52
    v_lshrrev_b32 v55, 1, v55
    v_or_b32 v54, v54, v55
    v_mul_u32_u24 v55, 1152, v53
    v_lshl_add_u32 v18, v54, 4, v55
    v_and_b32 v54, 7, v1
    v_lshl_add_u32 v55, v54, 4, v55
    v_add_u32 v55, 1024, v55
    v_lshrrev_b32 v54, 1, v1
    v_xor_b32 v54, v54, v1
    v_and_b32 v54, 8, v54
    v_cmp_eq_u32 vcc, 0, v54
    s_lshl_b32 s44, s32, 5
    s_add_u32 s44, s44, s33
    v_cndmask_b32 v19, v96, v55, vcc
    s_lshl_b32 s12, s38, 6
    s_add_u32 s12, s12, s44
    s_lshl_b32 s14, s12, 7
    s_add_u32 s14, s14, 13942784
    s_lshl_b32 s12, s12, 10
    s_add_u32 s12, s12, 9748480
    s_add_u32 s13, s12, 65536
    s_lshl_b32 s16, s30, 1
    s_add_u32 s16, s16, s37
    s_lshl_b32 s16, s16, 6
    s_lshl_b32 s44, s39, 4
    s_add_u32 s16, s16, s44
    s_lshl_b32 s17, s16, 7
    s_add_u32 s17, s17, 13942784
    s_lshl_b32 s16, s16, 10
    s_add_u32 s16, s16, 9748480

    s_mov_b32 s8, 0
    s_and_b32 s8, s8, 3
    s_lshl_b32 s8, s8, 12
    s_add_u32 s8, s8, s16
    s_mov_b32 s9, 1
    s_and_b32 s9, s9, 3
    s_lshl_b32 s9, s9, 12
    s_add_u32 s9, s9, s16
    s_mov_b32 s10, 2
    s_and_b32 s10, s10, 3
    s_lshl_b32 s10, s10, 12
    s_add_u32 s10, s10, s16
    s_mov_b32 s11, 3
    s_and_b32 s11, s11, 3
    s_lshl_b32 s11, s11, 12
    s_add_u32 s11, s11, s16
    s_mul_i32 s18, s31, 165888
    s_mul_i32 s44, s39, 2304
    s_add_u32 s18, s18, s44
    s_add_u32 s18, s18, 14623744
    s_mul_i32 s28, s31, 144
    s_mov_b32 s24, s6
    s_mov_b32 s25, s7
    s_mov_b32 s26, 2359296
    s_mov_b32 s27, 0x00020000
    s_mov_b32 s50, 0
    s_mov_b32 s51, -1
    s_mov_b32 s52, 0x5d800000
    s_mov_b32 s53, 0x2b800000

    v_mov_b32 v64, 0
    v_mov_b32 v65, 0
    v_mov_b32 v66, 0
    v_mov_b32 v67, 0
    v_mov_b32 v68, 0
    v_mov_b32 v69, 0
    v_mov_b32 v70, 0
    v_mov_b32 v71, 0
    v_mov_b32 v72, 0
    v_mov_b32 v73, 0
    v_mov_b32 v74, 0
    v_mov_b32 v75, 0
    v_mov_b32 v76, 0
    v_mov_b32 v77, 0
    v_mov_b32 v78, 0
    v_mov_b32 v79, 0
    v_mov_b32 v80, 0
    v_mov_b32 v81, 0
    v_mov_b32 v82, 0
    v_mov_b32 v83, 0
    v_mov_b32 v84, 0
    v_mov_b32 v85, 0
    v_mov_b32 v86, 0
    v_mov_b32 v87, 0
    v_mov_b32 v88, 0
    v_mov_b32 v89, 0
    v_mov_b32 v90, 0
    v_mov_b32 v91, 0
    v_mov_b32 v92, 0
    v_mov_b32 v93, 0
    v_mov_b32 v94, 0
    v_mov_b32 v95, 0
    v_mov_b32 v152, 0
    v_mov_b32 v153, 0
    v_mov_b32 v154, 0
    v_mov_b32 v155, 0
    v_mov_b32 v156, 0
    v_mov_b32 v157, 0
    v_mov_b32 v158, 0
    v_mov_b32 v159, 0
    v_mov_b32 v48, 0
    v_mov_b32 v49, 0
    v_mov_b32 v50, 0
    v_mov_b32 v51, 0
    s_waitcnt vmcnt(4)
    v_mfma_f32_32x32x4_2b_bf16 v[96:127], v[24:25], v[16:17], 0 cbsz:1 abid:0
    s_nop 15
    s_nop 1
    v_mfma_f32_32x32x16_bf16 v[96:111], v[28:31], v[8:11], v[96:111]
    v_mfma_f32_32x32x16_bf16 v[112:127], v[28:31], v[12:15], v[112:127]
    s_nop 11
    v_max3_f32 v52, v96, v97, v98
    v_max3_f32 v52, v52, v99, v100
    v_max3_f32 v52, v52, v101, v102
    v_max3_f32 v52, v52, v103, v104
    v_max3_f32 v52, v52, v105, v106
    v_max3_f32 v52, v52, v107, v108
    v_max3_f32 v52, v52, v109, v110
    v_max_f32 v52, v52, v111
    v_max3_f32 v53, v112, v113, v114
    v_max3_f32 v53, v53, v115, v116
    v_max3_f32 v53, v53, v117, v118
    v_max3_f32 v53, v53, v119, v120
    v_max3_f32 v53, v53, v121, v122
    v_max3_f32 v53, v53, v123, v124
    v_max3_f32 v53, v53, v125, v126
    v_max_f32 v53, v53, v127
    s_nop 1
    v_permlane32_swap_b32 v52, v53
    s_nop 0
    v_max_f32 v52, v52, v53
    v_and_b32 v53, 0xffff0000, v52
    v_sub_f32 v54, v53, v52
    v_xor_b32 v53, 0x80000000, v53
    v_cvt_pk_bf16_f32 v17, v53, v54
    v_and_b32 v54, 0xffff0000, v17
    v_add_f32 v54, v53, v54
    v_mov_b32 v55, v54
    s_nop 1
    v_permlane32_swap_b32 v54, v55
    s_nop 0

    v_pk_add_f32 v[96:97], v[96:97], v[54:55] op_sel:[0,0] op_sel_hi:[1,0]
    v_pk_add_f32 v[98:99], v[98:99], v[54:55] op_sel:[0,0] op_sel_hi:[1,0]
    v_pk_add_f32 v[100:101], v[100:101], v[54:55] op_sel:[0,0] op_sel_hi:[1,0]
    v_pk_add_f32 v[102:103], v[102:103], v[54:55] op_sel:[0,0] op_sel_hi:[1,0]
    v_pk_add_f32 v[104:105], v[104:105], v[54:55] op_sel:[0,0] op_sel_hi:[1,0]
    v_pk_add_f32 v[106:107], v[106:107], v[54:55] op_sel:[0,0] op_sel_hi:[1,0]
    v_pk_add_f32 v[108:109], v[108:109], v[54:55] op_sel:[0,0] op_sel_hi:[1,0]
    v_pk_add_f32 v[110:111], v[110:111], v[54:55] op_sel:[0,0] op_sel_hi:[1,0]
    v_pk_add_f32 v[112:113], v[112:113], v[54:55] op_sel:[0,1] op_sel_hi:[1,1]
    v_pk_add_f32 v[114:115], v[114:115], v[54:55] op_sel:[0,1] op_sel_hi:[1,1]
    v_pk_add_f32 v[116:117], v[116:117], v[54:55] op_sel:[0,1] op_sel_hi:[1,1]
    v_pk_add_f32 v[118:119], v[118:119], v[54:55] op_sel:[0,1] op_sel_hi:[1,1]
    v_pk_add_f32 v[120:121], v[120:121], v[54:55] op_sel:[0,1] op_sel_hi:[1,1]
    v_pk_add_f32 v[122:123], v[122:123], v[54:55] op_sel:[0,1] op_sel_hi:[1,1]
    v_pk_add_f32 v[124:125], v[124:125], v[54:55] op_sel:[0,1] op_sel_hi:[1,1]
    v_pk_add_f32 v[126:127], v[126:127], v[54:55] op_sel:[0,1] op_sel_hi:[1,1]
    s_mov_b32 s40, 0
    s_mov_b32 s41, 201
    s_waitcnt vmcnt(0) lgkmcnt(0)
    s_barrier
    ds_read_b128 v[36:39], v4 offset:9216
    ds_read_b128 v[40:43], v4 offset:9824
    ds_read_b128 v[32:35], v2 offset:1024
    s_setprio 3

.p2align 6
L2_loop:
    s_waitcnt lgkmcnt(0)
    v_exp_f32 v96, v96
    v_exp_f32 v97, v97
    v_smfmac_f32_32x32x32_bf16 v[80:95], v[48:51], v[152:159], v5
    ds_read_b128 v[44:47], v4 offset:10432
    v_exp_f32 v98, v98
    v_exp_f32 v99, v99
    v_exp_f32 v100, v100
    v_mfma_f32_32x32x4_2b_bf16 v[128:159], v[24:25], v[16:17], 0 cbsz:1 abid:1
    ds_read_b128 v[48:51], v4 offset:11040
    v_exp_f32 v101, v101
    v_exp_f32 v102, v102
    v_exp_f32 v103, v103
    v_exp_f32 v104, v104
    v_exp_f32 v105, v105
    v_exp_f32 v106, v106
    v_exp_f32 v107, v107
    v_exp_f32 v108, v108
    v_smfmac_f32_32x32x32_bf16 v[64:79], v[36:39], v[96:103], v5
    ds_read_b128 v[28:31], v2 offset:2048
    v_exp_f32 v109, v109
    v_exp_f32 v110, v110
    v_exp_f32 v111, v111
    v_exp_f32 v112, v112
    v_exp_f32 v113, v113
    v_smfmac_f32_32x32x32_bf16 v[64:79], v[40:43], v[104:111], v5
    ds_read_b32 v26, v3 offset:8448
    v_exp_f32 v114, v114
    v_exp_f32 v115, v115
    v_exp_f32 v116, v116
    v_exp_f32 v117, v117
    v_mfma_f32_32x32x16_bf16 v[128:143], v[32:35], v[8:11], v[128:143]
    v_exp_f32 v118, v118
    v_exp_f32 v119, v119
    v_exp_f32 v120, v120
    v_exp_f32 v121, v121
    v_smfmac_f32_32x32x32_bf16 v[80:95], v[36:39], v[112:119], v5
    v_exp_f32 v122, v122
    v_exp_f32 v123, v123
    v_exp_f32 v124, v124
    v_mfma_f32_32x32x16_bf16 v[144:159], v[32:35], v[12:15], v[144:159]
    v_exp_f32 v125, v125
    v_exp_f32 v126, v126
    v_exp_f32 v127, v127
L2_it1:
    s_waitcnt lgkmcnt(0)
    v_exp_f32 v128, v128
    v_exp_f32 v129, v129
    v_smfmac_f32_32x32x32_bf16 v[80:95], v[40:43], v[120:127], v5
    ds_read_b128 v[36:39], v4 offset:11648
    v_exp_f32 v130, v130
    v_exp_f32 v131, v131
    v_exp_f32 v132, v132
    v_mfma_f32_32x32x4_2b_bf16 v[96:127], v[26:27], v[16:17], 0 cbsz:1 abid:0
    ds_read_b128 v[40:43], v4 offset:12256
    v_exp_f32 v133, v133
    v_exp_f32 v134, v134
    v_exp_f32 v135, v135
    v_exp_f32 v136, v136
    v_exp_f32 v137, v137
    v_exp_f32 v138, v138
    v_exp_f32 v139, v139
    v_exp_f32 v140, v140
    v_smfmac_f32_32x32x32_bf16 v[64:79], v[44:47], v[128:135], v5
    ds_read_b128 v[32:35], v2 offset:3072
    v_exp_f32 v141, v141
    v_exp_f32 v142, v142
    v_exp_f32 v143, v143
    v_exp_f32 v144, v144
    v_exp_f32 v145, v145
    v_smfmac_f32_32x32x32_bf16 v[64:79], v[48:51], v[136:143], v5
    v_exp_f32 v146, v146
    v_exp_f32 v147, v147
    v_exp_f32 v148, v148
    v_exp_f32 v149, v149
    v_mfma_f32_32x32x16_bf16 v[96:111], v[28:31], v[8:11], v[96:111]
    v_exp_f32 v150, v150
    v_exp_f32 v151, v151
    v_exp_f32 v152, v152
    v_exp_f32 v153, v153
    v_smfmac_f32_32x32x32_bf16 v[80:95], v[44:47], v[144:151], v5
    v_exp_f32 v154, v154
    v_exp_f32 v155, v155
    v_exp_f32 v156, v156
    v_mfma_f32_32x32x16_bf16 v[112:127], v[28:31], v[12:15], v[112:127]
    v_exp_f32 v157, v157
    v_exp_f32 v158, v158
    v_exp_f32 v159, v159
    s_waitcnt lgkmcnt(0)
    v_exp_f32 v96, v96
    v_exp_f32 v97, v97
    v_smfmac_f32_32x32x32_bf16 v[80:95], v[48:51], v[152:159], v5
    ds_read_b128 v[44:47], v4 offset:12864
    v_exp_f32 v98, v98
    v_exp_f32 v99, v99
    v_exp_f32 v100, v100
    v_mfma_f32_32x32x4_2b_bf16 v[128:159], v[26:27], v[16:17], 0 cbsz:1 abid:1
    ds_read_b128 v[48:51], v4 offset:13472
    v_exp_f32 v101, v101
    v_exp_f32 v102, v102
    v_exp_f32 v103, v103
    v_exp_f32 v104, v104
    v_exp_f32 v105, v105
    v_exp_f32 v106, v106
    v_exp_f32 v107, v107
    v_exp_f32 v108, v108
    v_smfmac_f32_32x32x32_bf16 v[64:79], v[36:39], v[96:103], v5
    ds_read_b128 v[28:31], v2 offset:4096
    v_exp_f32 v109, v109
    v_exp_f32 v110, v110
    v_exp_f32 v111, v111
    v_exp_f32 v112, v112
    v_exp_f32 v113, v113
    v_smfmac_f32_32x32x32_bf16 v[64:79], v[40:43], v[104:111], v5
    ds_read_b32 v24, v3 offset:8704
    v_exp_f32 v114, v114
    v_exp_f32 v115, v115
    v_exp_f32 v116, v116
    v_exp_f32 v117, v117
    v_mfma_f32_32x32x16_bf16 v[128:143], v[32:35], v[8:11], v[128:143]
    v_exp_f32 v118, v118
    v_exp_f32 v119, v119
    v_exp_f32 v120, v120
    v_exp_f32 v121, v121
    v_smfmac_f32_32x32x32_bf16 v[80:95], v[36:39], v[112:119], v5
    v_exp_f32 v122, v122
    v_exp_f32 v123, v123
    v_exp_f32 v124, v124
    v_mfma_f32_32x32x16_bf16 v[144:159], v[32:35], v[12:15], v[144:159]
    v_exp_f32 v125, v125
    v_exp_f32 v126, v126
    v_exp_f32 v127, v127
    s_waitcnt lgkmcnt(0)
    v_exp_f32 v128, v128
    v_exp_f32 v129, v129
    v_smfmac_f32_32x32x32_bf16 v[80:95], v[40:43], v[120:127], v5
    ds_read_b128 v[36:39], v4 offset:14080
    v_exp_f32 v130, v130
    v_exp_f32 v131, v131
    v_exp_f32 v132, v132
    v_mfma_f32_32x32x4_2b_bf16 v[96:127], v[24:25], v[16:17], 0 cbsz:1 abid:0
    ds_read_b128 v[40:43], v4 offset:14688
    v_exp_f32 v133, v133
    v_exp_f32 v134, v134
    v_exp_f32 v135, v135
    v_exp_f32 v136, v136
    v_exp_f32 v137, v137
    v_exp_f32 v138, v138
    v_exp_f32 v139, v139
    v_exp_f32 v140, v140
    v_smfmac_f32_32x32x32_bf16 v[64:79], v[44:47], v[128:135], v5
    ds_read_b128 v[32:35], v2 offset:5120
    v_exp_f32 v141, v141
    v_exp_f32 v142, v142
    v_exp_f32 v143, v143
    v_exp_f32 v144, v144
    v_exp_f32 v145, v145
    v_smfmac_f32_32x32x32_bf16 v[64:79], v[48:51], v[136:143], v5
    v_exp_f32 v146, v146
    v_exp_f32 v147, v147
    v_exp_f32 v148, v148
    v_exp_f32 v149, v149
    v_mfma_f32_32x32x16_bf16 v[96:111], v[28:31], v[8:11], v[96:111]
    v_exp_f32 v150, v150
    v_exp_f32 v151, v151
    v_exp_f32 v152, v152
    v_exp_f32 v153, v153
    v_smfmac_f32_32x32x32_bf16 v[80:95], v[44:47], v[144:151], v5
    v_exp_f32 v154, v154
    v_exp_f32 v155, v155
    v_exp_f32 v156, v156
    v_mfma_f32_32x32x16_bf16 v[112:127], v[28:31], v[12:15], v[112:127]
    v_exp_f32 v157, v157
    v_exp_f32 v158, v158
    v_exp_f32 v159, v159
    s_waitcnt lgkmcnt(0)
    v_exp_f32 v96, v96
    v_exp_f32 v97, v97
    v_smfmac_f32_32x32x32_bf16 v[80:95], v[48:51], v[152:159], v5
    ds_read_b128 v[44:47], v4 offset:15296
    v_exp_f32 v98, v98
    v_exp_f32 v99, v99
    v_exp_f32 v100, v100
    v_mfma_f32_32x32x4_2b_bf16 v[128:159], v[24:25], v[16:17], 0 cbsz:1 abid:1
    ds_read_b128 v[48:51], v4 offset:15904
    v_exp_f32 v101, v101
    v_exp_f32 v102, v102
    v_exp_f32 v103, v103
    v_exp_f32 v104, v104
    v_exp_f32 v105, v105
    v_exp_f32 v106, v106
    v_exp_f32 v107, v107
    v_exp_f32 v108, v108
    v_smfmac_f32_32x32x32_bf16 v[64:79], v[36:39], v[96:103], v5
    ds_read_b128 v[28:31], v2 offset:6144
    v_exp_f32 v109, v109
    v_exp_f32 v110, v110
    v_exp_f32 v111, v111
    v_exp_f32 v112, v112
    v_exp_f32 v113, v113
    v_smfmac_f32_32x32x32_bf16 v[64:79], v[40:43], v[104:111], v5
    ds_read_b32 v26, v3 offset:8960
    v_exp_f32 v114, v114
    v_exp_f32 v115, v115
    v_exp_f32 v116, v116
    v_exp_f32 v117, v117
    v_mfma_f32_32x32x16_bf16 v[128:143], v[32:35], v[8:11], v[128:143]
    v_exp_f32 v118, v118
    v_exp_f32 v119, v119
    v_exp_f32 v120, v120
    v_exp_f32 v121, v121
    v_smfmac_f32_32x32x32_bf16 v[80:95], v[36:39], v[112:119], v5
    v_exp_f32 v122, v122
    v_exp_f32 v123, v123
    v_exp_f32 v124, v124
    v_mfma_f32_32x32x16_bf16 v[144:159], v[32:35], v[12:15], v[144:159]
    v_exp_f32 v125, v125
    v_exp_f32 v126, v126
    v_exp_f32 v127, v127
    s_waitcnt lgkmcnt(0)
    v_exp_f32 v128, v128
    v_exp_f32 v129, v129
    v_smfmac_f32_32x32x32_bf16 v[80:95], v[40:43], v[120:127], v5
    ds_read_b128 v[36:39], v4 offset:16512
    v_exp_f32 v130, v130
    v_exp_f32 v131, v131
    v_exp_f32 v132, v132
    v_mfma_f32_32x32x4_2b_bf16 v[96:127], v[26:27], v[16:17], 0 cbsz:1 abid:0
    ds_read_b128 v[40:43], v4 offset:17120
    v_exp_f32 v133, v133
    v_exp_f32 v134, v134
    v_exp_f32 v135, v135
    v_exp_f32 v136, v136
    v_exp_f32 v137, v137
    v_exp_f32 v138, v138
    v_exp_f32 v139, v139
    v_exp_f32 v140, v140
    v_smfmac_f32_32x32x32_bf16 v[64:79], v[44:47], v[128:135], v5
    ds_read_b128 v[32:35], v2 offset:7168
    v_exp_f32 v141, v141
    v_exp_f32 v142, v142
    v_exp_f32 v143, v143
    v_exp_f32 v144, v144
    v_exp_f32 v145, v145
    v_smfmac_f32_32x32x32_bf16 v[64:79], v[48:51], v[136:143], v5
    v_exp_f32 v146, v146
    v_exp_f32 v147, v147
    v_exp_f32 v148, v148
    v_exp_f32 v149, v149
    v_mfma_f32_32x32x16_bf16 v[96:111], v[28:31], v[8:11], v[96:111]
    v_exp_f32 v150, v150
    v_exp_f32 v151, v151
    v_exp_f32 v152, v152
    v_exp_f32 v153, v153
    v_smfmac_f32_32x32x32_bf16 v[80:95], v[44:47], v[144:151], v5
    v_exp_f32 v154, v154
    v_exp_f32 v155, v155
    v_exp_f32 v156, v156
    v_mfma_f32_32x32x16_bf16 v[112:127], v[28:31], v[12:15], v[112:127]
    v_exp_f32 v157, v157
    v_exp_f32 v158, v158
    v_exp_f32 v159, v159
    s_bitcmp1_b32 s41, s40
    s_cbranch_scc1 L2_hook
L2_hookret:
    s_waitcnt lgkmcnt(0)
    v_exp_f32 v96, v96
    v_exp_f32 v97, v97
    v_smfmac_f32_32x32x32_bf16 v[80:95], v[48:51], v[152:159], v5
    ds_read_b128 v[44:47], v4 offset:17728
    v_exp_f32 v98, v98
    v_exp_f32 v99, v99
    v_exp_f32 v100, v100
    v_mfma_f32_32x32x4_2b_bf16 v[128:159], v[26:27], v[16:17], 0 cbsz:1 abid:1
    ds_read_b128 v[48:51], v4 offset:18336
    v_exp_f32 v101, v101
    v_exp_f32 v102, v102
    v_exp_f32 v103, v103
    v_exp_f32 v104, v104
    v_exp_f32 v105, v105
    v_exp_f32 v106, v106
    v_exp_f32 v107, v107
    v_exp_f32 v108, v108
    v_smfmac_f32_32x32x32_bf16 v[64:79], v[36:39], v[96:103], v5
    ds_read_b128 v[28:31], v2 offset:18944
    v_exp_f32 v109, v109
    v_exp_f32 v110, v110
    v_exp_f32 v111, v111
    v_exp_f32 v112, v112
    v_exp_f32 v113, v113
    v_smfmac_f32_32x32x32_bf16 v[64:79], v[40:43], v[104:111], v5
    ds_read_b32 v24, v3 offset:27136
    v_exp_f32 v114, v114
    v_exp_f32 v115, v115
    v_exp_f32 v116, v116
    v_exp_f32 v117, v117
    v_mfma_f32_32x32x16_bf16 v[128:143], v[32:35], v[8:11], v[128:143]
    v_exp_f32 v118, v118
    v_exp_f32 v119, v119
    v_exp_f32 v120, v120
    v_exp_f32 v121, v121
    v_smfmac_f32_32x32x32_bf16 v[80:95], v[36:39], v[112:119], v5
    v_exp_f32 v122, v122
    v_exp_f32 v123, v123
    v_exp_f32 v124, v124
    v_mfma_f32_32x32x16_bf16 v[144:159], v[32:35], v[12:15], v[144:159]
    v_exp_f32 v125, v125
    v_exp_f32 v126, v126
    v_exp_f32 v127, v127
    s_waitcnt lgkmcnt(0)
    v_exp_f32 v128, v128
    v_exp_f32 v129, v129
    v_smfmac_f32_32x32x32_bf16 v[80:95], v[40:43], v[120:127], v5
    ds_read_b128 v[36:39], v4 offset:28160
    v_exp_f32 v130, v130
    v_exp_f32 v131, v131
    v_exp_f32 v132, v132
    v_mfma_f32_32x32x4_2b_bf16 v[96:127], v[24:25], v[16:17], 0 cbsz:1 abid:0
    ds_read_b128 v[40:43], v4 offset:28768
    v_exp_f32 v133, v133
    v_exp_f32 v134, v134
    v_exp_f32 v135, v135
    v_exp_f32 v136, v136
    v_exp_f32 v137, v137
    v_exp_f32 v138, v138
    v_exp_f32 v139, v139
    v_exp_f32 v140, v140
    v_smfmac_f32_32x32x32_bf16 v[64:79], v[44:47], v[128:135], v5
    ds_read_b128 v[32:35], v2 offset:19968
    v_exp_f32 v141, v141
    v_exp_f32 v142, v142
    v_exp_f32 v143, v143
    v_exp_f32 v144, v144
    v_exp_f32 v145, v145
    v_smfmac_f32_32x32x32_bf16 v[64:79], v[48:51], v[136:143], v5
    v_exp_f32 v146, v146
    v_exp_f32 v147, v147
    v_exp_f32 v148, v148
    v_exp_f32 v149, v149
    v_mfma_f32_32x32x16_bf16 v[96:111], v[28:31], v[8:11], v[96:111]
    v_exp_f32 v150, v150
    v_exp_f32 v151, v151
    v_exp_f32 v152, v152
    v_exp_f32 v153, v153
    v_smfmac_f32_32x32x32_bf16 v[80:95], v[44:47], v[144:151], v5
    v_exp_f32 v154, v154
    v_exp_f32 v155, v155
    v_exp_f32 v156, v156
    v_mfma_f32_32x32x16_bf16 v[112:127], v[28:31], v[12:15], v[112:127]
    v_exp_f32 v157, v157
    v_exp_f32 v158, v158
    v_exp_f32 v159, v159
    v_add_u32 v2, 18944, v2
    v_add_u32 v3, 18944, v3
    v_add_u32 v4, 18944, v4
    s_add_u32 s40, s40, 1

    s_cmp_lt_u32 s40, 8
    s_cbranch_scc1 L2_loop
    v_smfmac_f32_32x32x32_bf16 v[80:95], v[48:51], v[152:159], v5
    s_setprio 3
    s_waitcnt lgkmcnt(0)
    v_cndmask_b32 v52, v74, v76, s[50:51]
    v_cmp_nlt_f32 s[54:55], v52, s52
    v_cmp_ngt_f32 s[58:59], v52, s53
    s_nop 6
    v_cndmask_b32 v53, v90, v92, s[50:51]
    v_cmp_nlt_f32 s[56:57], v53, s52
    v_cmp_ngt_f32 s[60:61], v53, s53
    s_or_b64 s[54:55], s[54:55], s[58:59]
    s_nop 2
    s_or_b64 s[56:57], s[56:57], s[60:61]
    s_or_b64 s[54:55], s[54:55], s[56:57]
    s_cbranch_scc1 L2_fallback

L2_norm:
    v_rcp_f32 v52, v52
    v_rcp_f32 v54, v53
    v_lshlrev_b32 v2, 4, v1

    v_pk_mul_f32 v[64:65], v[64:65], v[52:53] op_sel_hi:[1,0]
    v_pk_mul_f32 v[66:67], v[66:67], v[52:53] op_sel_hi:[1,0]
    v_pk_mul_f32 v[68:69], v[68:69], v[52:53] op_sel_hi:[1,0]
    v_pk_mul_f32 v[70:71], v[70:71], v[52:53] op_sel_hi:[1,0]
    v_pk_mul_f32 v[72:73], v[72:73], v[52:53] op_sel_hi:[1,0]
    v_cvt_pk_bf16_f32 v24, v64, v65
    v_cvt_pk_bf16_f32 v25, v66, v67
    v_cvt_pk_bf16_f32 v26, v68, v69
    v_cvt_pk_bf16_f32 v27, v70, v71
    v_cvt_pk_bf16_f32 v28, v72, v73
    v_min_u32 v24, -2, v24
    buffer_store_dwordx4 v[24:27], v2, s[20:23], s12 offen sc0 sc1
    v_pk_mul_f32 v[80:81], v[80:81], v[54:55] op_sel_hi:[1,0]
    v_pk_mul_f32 v[82:83], v[82:83], v[54:55] op_sel_hi:[1,0]
    v_pk_mul_f32 v[84:85], v[84:85], v[54:55] op_sel_hi:[1,0]
    v_pk_mul_f32 v[86:87], v[86:87], v[54:55] op_sel_hi:[1,0]
    v_pk_mul_f32 v[88:89], v[88:89], v[54:55] op_sel_hi:[1,0]
    v_cvt_pk_bf16_f32 v32, v80, v81
    v_cvt_pk_bf16_f32 v33, v82, v83
    v_cvt_pk_bf16_f32 v34, v84, v85
    v_cvt_pk_bf16_f32 v35, v86, v87
    v_cvt_pk_bf16_f32 v36, v88, v89
    v_min_u32 v32, -2, v32
    buffer_store_dwordx4 v[32:35], v2, s[20:23], s13 offen sc0 sc1
    v_permlane32_swap_b32 v28, v36
    s_nop 0
    v_min_u32 v28, -2, v28
    buffer_store_dword v28, v20, s[20:23], s14 offen sc0 sc1

    ds_add_u32 v6, v7 offset:16
    s_setprio 0
    s_mov_b32 s45, 0
    s_mov_b32 s42, 63
    s_mov_b32 s49, -1
    s_mul_i32 s44, s39, 2304
    s_add_u32 s44, s44, 151552
    v_add_u32 v3, s19, v18
    v_add_u32 v4, s19, v19
    v_add_u32 v5, s44, v18
    v_add_u32 v22, s44, v19
    s_lshl_b32 s44, s39, 2
    v_add_u32 v17, s44, v6

    buffer_load_dwordx4 v[8:11], v18, s[20:23], s18 offen sc1
    buffer_load_dwordx4 v[12:15], v18, s[20:23], s18 offen offset:512 sc1
    buffer_load_dwordx4 v[128:131], v19, s[20:23], s18 offen sc1
L2_w8:
    ds_read_b32 v16, v6 offset:16
    s_waitcnt lgkmcnt(0)
    v_readfirstlane_b32 s55, v16
    s_nop 3
    s_cmp_ge_u32 s55, 512
    s_cbranch_scc1 L2_w8ok
    s_sleep 1
    s_branch L2_w8

L2_w8ok:
    buffer_load_dwordx4 v[64:67], v2, s[20:23], s8 offen offset:0 sc1
    buffer_load_dwordx4 v[68:71], v2, s[20:23], s8 offen offset:1024 sc1
    buffer_load_dwordx4 v[72:75], v2, s[20:23], s8 offen offset:2048 sc1
    buffer_load_dwordx4 v[76:79], v2, s[20:23], s8 offen offset:3072 sc1
    v_mov_b32 v132, 0
    v_mov_b32 v133, 0
    v_mov_b32 v134, 0
    v_mov_b32 v135, 0
    v_mov_b32 v136, 0
    v_mov_b32 v137, 0
    v_mov_b32 v138, 0
    v_mov_b32 v139, 0
    v_mov_b32 v140, 0
    v_mov_b32 v141, 0
    v_mov_b32 v142, 0
    v_mov_b32 v143, 0
    v_mov_b32 v144, 0
    v_mov_b32 v145, 0
    v_mov_b32 v146, 0
    v_mov_b32 v147, 0
    v_mov_b32 v148, 0
    v_mov_b32 v149, 0
    v_mov_b32 v150, 0
    v_mov_b32 v151, 0
    v_mov_b32 v152, 0
    v_mov_b32 v153, 0
    v_mov_b32 v154, 0
    v_mov_b32 v155, 0
    v_mov_b32 v156, 0
    v_mov_b32 v157, 0
    v_mov_b32 v158, 0
    v_mov_b32 v159, 0
    v_mov_b32 v160, 0
    v_mov_b32 v161, 0
    v_mov_b32 v162, 0
    v_mov_b32 v163, 0
    v_mov_b32 v164, 0
    v_mov_b32 v165, 0
    v_mov_b32 v166, 0
    v_mov_b32 v167, 0
L2_wl:
    ds_read_b32 v16, v6 offset:8
    s_waitcnt lgkmcnt(0)
    v_readfirstlane_b32 s55, v16
    s_nop 3
    s_cmp_ge_u32 s55, 1
    s_cbranch_scc1 L2_wlok
    s_sleep 1
    s_branch L2_wl

L2_wlok:
    buffer_load_dwordx4 v[80:83], v2, s[20:23], s9 offen offset:0 sc1
    buffer_load_dwordx4 v[84:87], v2, s[20:23], s9 offen offset:1024 sc1
    buffer_load_dwordx4 v[88:91], v2, s[20:23], s9 offen offset:2048 sc1
    buffer_load_dwordx4 v[92:95], v2, s[20:23], s9 offen offset:3072 sc1
    s_cmp_ge_u32 s35, 4
    s_cbranch_scc0 L2_ypr
    s_setprio 1
L2_ypr:
L2_round:
    ds_read_b128 v[24:27], v3 offset:0
    ds_read_b128 v[28:31], v3 offset:512
    ds_read_b128 v[32:35], v4 offset:0
    ds_read_b128 v[36:39], v3 offset:2304
    ds_read_b128 v[40:43], v3 offset:2816
    ds_read_b128 v[44:47], v4 offset:2304
L2_u0:
    s_waitcnt vmcnt(4)
    s_cmp_lg_u32 s45, 0
    s_cbranch_scc1 L2_nl0
    buffer_load_dwordx4 v[96:99], v2, s[20:23], s10 offen offset:0 sc1
    buffer_load_dwordx4 v[100:103], v2, s[20:23], s10 offen offset:1024 sc1
    buffer_load_dwordx4 v[104:107], v2, s[20:23], s10 offen offset:2048 sc1
    buffer_load_dwordx4 v[108:111], v2, s[20:23], s10 offen offset:3072 sc1
L2_nl0:
    s_bitcmp1_b32 s42, 0
    s_cbranch_scc0 L2_sk0
    v_max3_u32 v16, v64, v68, v72
    v_max_u32 v16, v16, v76
    v_cmp_eq_u32 vcc, s49, v16
    s_nop 4
    s_cbranch_vccnz L2_sk0
    s_bitset0_b32 s42, 0
    s_waitcnt lgkmcnt(5)
    v_mfma_f32_32x32x16_bf16 v[132:147], v[24:27], v[64:67], v[132:147]
    ds_read_b128 v[24:27], v3 offset:4608
    s_waitcnt lgkmcnt(5)
    v_mfma_f32_32x32x16_bf16 v[148:163], v[28:31], v[64:67], v[148:163]
    ds_read_b128 v[28:31], v3 offset:5120
    s_waitcnt lgkmcnt(5)
    v_mfma_f32_16x16x32_bf16 v[164:167], v[32:35], v[64:67], v[164:167]
    ds_read_b128 v[32:35], v4 offset:4608
    s_waitcnt lgkmcnt(5)
    v_mfma_f32_32x32x16_bf16 v[132:147], v[36:39], v[68:71], v[132:147]
    ds_read_b128 v[36:39], v3 offset:6912
    s_waitcnt lgkmcnt(5)
    v_mfma_f32_32x32x16_bf16 v[148:163], v[40:43], v[68:71], v[148:163]
    ds_read_b128 v[40:43], v3 offset:7424
    s_waitcnt lgkmcnt(5)
    v_mfma_f32_16x16x32_bf16 v[164:167], v[44:47], v[68:71], v[164:167]
    ds_read_b128 v[44:47], v4 offset:6912
    s_waitcnt lgkmcnt(5)
    v_mfma_f32_32x32x16_bf16 v[132:147], v[24:27], v[72:75], v[132:147]
    ds_read_b128 v[24:27], v3 offset:9216
    s_waitcnt lgkmcnt(5)
    v_mfma_f32_32x32x16_bf16 v[148:163], v[28:31], v[72:75], v[148:163]
    ds_read_b128 v[28:31], v3 offset:9728
    s_waitcnt lgkmcnt(5)
    v_mfma_f32_16x16x32_bf16 v[164:167], v[32:35], v[72:75], v[164:167]
    ds_read_b128 v[32:35], v4 offset:9216
    s_waitcnt lgkmcnt(5)
    v_mfma_f32_32x32x16_bf16 v[132:147], v[36:39], v[76:79], v[132:147]
    ds_read_b128 v[36:39], v3 offset:11520
    s_waitcnt lgkmcnt(5)
    v_mfma_f32_32x32x16_bf16 v[148:163], v[40:43], v[76:79], v[148:163]
    ds_read_b128 v[40:43], v3 offset:12032
    s_waitcnt lgkmcnt(5)
    v_mfma_f32_16x16x32_bf16 v[164:167], v[44:47], v[76:79], v[164:167]
    ds_read_b128 v[44:47], v4 offset:11520
L2_u1:
    s_waitcnt vmcnt(4)
    s_cmp_lg_u32 s45, 0
    s_cbranch_scc1 L2_nl1
    buffer_load_dwordx4 v[112:115], v2, s[20:23], s11 offen offset:0 sc1
    buffer_load_dwordx4 v[116:119], v2, s[20:23], s11 offen offset:1024 sc1
    buffer_load_dwordx4 v[120:123], v2, s[20:23], s11 offen offset:2048 sc1
    buffer_load_dwordx4 v[124:127], v2, s[20:23], s11 offen offset:3072 sc1
L2_nl1:
    s_bitcmp1_b32 s42, 1
    s_cbranch_scc0 L2_sk1
    v_max3_u32 v16, v80, v84, v88
    v_max_u32 v16, v16, v92
    v_cmp_eq_u32 vcc, s49, v16
    s_nop 4
    s_cbranch_vccnz L2_sk1
    s_bitset0_b32 s42, 1
    s_waitcnt lgkmcnt(5)
    v_mfma_f32_32x32x16_bf16 v[132:147], v[24:27], v[80:83], v[132:147]
    ds_read_b128 v[24:27], v3 offset:13824
    s_waitcnt lgkmcnt(5)
    v_mfma_f32_32x32x16_bf16 v[148:163], v[28:31], v[80:83], v[148:163]
    ds_read_b128 v[28:31], v3 offset:14336
    s_waitcnt lgkmcnt(5)
    v_mfma_f32_16x16x32_bf16 v[164:167], v[32:35], v[80:83], v[164:167]
    ds_read_b128 v[32:35], v4 offset:13824
    s_waitcnt lgkmcnt(5)
    v_mfma_f32_32x32x16_bf16 v[132:147], v[36:39], v[84:87], v[132:147]
    ds_read_b128 v[36:39], v3 offset:16128
    s_waitcnt lgkmcnt(5)
    v_mfma_f32_32x32x16_bf16 v[148:163], v[40:43], v[84:87], v[148:163]
    ds_read_b128 v[40:43], v3 offset:16640
    s_waitcnt lgkmcnt(5)
    v_mfma_f32_16x16x32_bf16 v[164:167], v[44:47], v[84:87], v[164:167]
    ds_read_b128 v[44:47], v4 offset:16128
    s_waitcnt lgkmcnt(5)
    v_mfma_f32_32x32x16_bf16 v[132:147], v[24:27], v[88:91], v[132:147]
    ds_read_b128 v[24:27], v3 offset:18432
    s_waitcnt lgkmcnt(5)
    v_mfma_f32_32x32x16_bf16 v[148:163], v[28:31], v[88:91], v[148:163]
    ds_read_b128 v[28:31], v3 offset:18944
    s_waitcnt lgkmcnt(5)
    v_mfma_f32_16x16x32_bf16 v[164:167], v[32:35], v[88:91], v[164:167]
    ds_read_b128 v[32:35], v4 offset:18432
    s_waitcnt lgkmcnt(5)
    v_mfma_f32_32x32x16_bf16 v[132:147], v[36:39], v[92:95], v[132:147]
    ds_read_b128 v[36:39], v3 offset:20736
    s_waitcnt lgkmcnt(5)
    v_mfma_f32_32x32x16_bf16 v[148:163], v[40:43], v[92:95], v[148:163]
    ds_read_b128 v[40:43], v3 offset:21248
    s_waitcnt lgkmcnt(5)
    v_mfma_f32_16x16x32_bf16 v[164:167], v[44:47], v[92:95], v[164:167]
    ds_read_b128 v[44:47], v4 offset:20736
L2_u2:
    s_waitcnt vmcnt(4)
    s_cmp_lg_u32 s45, 0
    s_cbranch_scc1 L2_nl2
    buffer_load_dword v48, v21, s[20:23], s17 offen offset:0 sc1
    buffer_load_dword v49, v21, s[20:23], s17 offen offset:128 sc1
    buffer_load_dword v50, v21, s[20:23], s17 offen offset:256 sc1
    buffer_load_dword v51, v21, s[20:23], s17 offen offset:384 sc1
    buffer_load_dword v52, v21, s[20:23], s17 offen offset:1024 sc1
    buffer_load_dword v53, v21, s[20:23], s17 offen offset:1152 sc1
    buffer_load_dword v54, v21, s[20:23], s17 offen offset:1280 sc1
    buffer_load_dword v55, v21, s[20:23], s17 offen offset:1408 sc1
L2_nl2:
    s_bitcmp1_b32 s42, 2
    s_cbranch_scc0 L2_sk2
    v_max3_u32 v16, v96, v100, v104
    v_max_u32 v16, v16, v108
    v_cmp_eq_u32 vcc, s49, v16
    s_nop 4
    s_cbranch_vccnz L2_sk2
    s_bitset0_b32 s42, 2
    s_waitcnt lgkmcnt(5)
    v_mfma_f32_32x32x16_bf16 v[132:147], v[24:27], v[96:99], v[132:147]
    ds_read_b128 v[24:27], v3 offset:23040
    s_waitcnt lgkmcnt(5)
    v_mfma_f32_32x32x16_bf16 v[148:163], v[28:31], v[96:99], v[148:163]
    ds_read_b128 v[28:31], v3 offset:23552
    s_waitcnt lgkmcnt(5)
    v_mfma_f32_16x16x32_bf16 v[164:167], v[32:35], v[96:99], v[164:167]
    ds_read_b128 v[32:35], v4 offset:23040
    s_waitcnt lgkmcnt(5)
    v_mfma_f32_32x32x16_bf16 v[132:147], v[36:39], v[100:103], v[132:147]
    ds_read_b128 v[36:39], v3 offset:25344
    s_waitcnt lgkmcnt(5)
    v_mfma_f32_32x32x16_bf16 v[148:163], v[40:43], v[100:103], v[148:163]
    ds_read_b128 v[40:43], v3 offset:25856
    s_waitcnt lgkmcnt(5)
    v_mfma_f32_16x16x32_bf16 v[164:167], v[44:47], v[100:103], v[164:167]
    ds_read_b128 v[44:47], v4 offset:25344
    s_waitcnt lgkmcnt(5)
    v_mfma_f32_32x32x16_bf16 v[132:147], v[24:27], v[104:107], v[132:147]
    ds_read_b128 v[24:27], v3 offset:27648
    s_waitcnt lgkmcnt(5)
    v_mfma_f32_32x32x16_bf16 v[148:163], v[28:31], v[104:107], v[148:163]
    ds_read_b128 v[28:31], v3 offset:28160
    s_waitcnt lgkmcnt(5)
    v_mfma_f32_16x16x32_bf16 v[164:167], v[32:35], v[104:107], v[164:167]
    ds_read_b128 v[32:35], v4 offset:27648
    s_waitcnt lgkmcnt(5)
    v_mfma_f32_32x32x16_bf16 v[132:147], v[36:39], v[108:111], v[132:147]
    ds_read_b128 v[36:39], v3 offset:29952
    s_waitcnt lgkmcnt(5)
    v_mfma_f32_32x32x16_bf16 v[148:163], v[40:43], v[108:111], v[148:163]
    ds_read_b128 v[40:43], v3 offset:30464
    s_waitcnt lgkmcnt(5)
    v_mfma_f32_16x16x32_bf16 v[164:167], v[44:47], v[108:111], v[164:167]
    ds_read_b128 v[44:47], v4 offset:29952
L2_u3:
    s_waitcnt vmcnt(8)
    s_bitcmp1_b32 s42, 3
    s_cbranch_scc0 L2_sk3
    v_max3_u32 v16, v112, v116, v120
    v_max_u32 v16, v16, v124
    v_cmp_eq_u32 vcc, s49, v16
    s_nop 4
    s_cbranch_vccnz L2_sk3
    s_bitset0_b32 s42, 3
    s_waitcnt lgkmcnt(5)
    v_mfma_f32_32x32x16_bf16 v[132:147], v[24:27], v[112:115], v[132:147]
    ds_read_b128 v[24:27], v3 offset:32256
    s_waitcnt lgkmcnt(5)
    v_mfma_f32_32x32x16_bf16 v[148:163], v[28:31], v[112:115], v[148:163]
    ds_read_b128 v[28:31], v3 offset:32768
    s_waitcnt lgkmcnt(5)
    v_mfma_f32_16x16x32_bf16 v[164:167], v[32:35], v[112:115], v[164:167]
    ds_read_b128 v[32:35], v4 offset:32256
    s_waitcnt lgkmcnt(5)
    v_mfma_f32_32x32x16_bf16 v[132:147], v[36:39], v[116:119], v[132:147]
    ds_read_b128 v[36:39], v3 offset:34560
    s_waitcnt lgkmcnt(5)
    v_mfma_f32_32x32x16_bf16 v[148:163], v[40:43], v[116:119], v[148:163]
    ds_read_b128 v[40:43], v3 offset:35072
    s_waitcnt lgkmcnt(5)
    v_mfma_f32_16x16x32_bf16 v[164:167], v[44:47], v[116:119], v[164:167]
    ds_read_b128 v[44:47], v4 offset:34560
    s_waitcnt lgkmcnt(5)
    v_mfma_f32_32x32x16_bf16 v[132:147], v[24:27], v[120:123], v[132:147]
    ds_read_b128 v[24:27], v5
    s_waitcnt lgkmcnt(5)
    v_mfma_f32_32x32x16_bf16 v[148:163], v[28:31], v[120:123], v[148:163]
    ds_read_b128 v[28:31], v5 offset:512
    s_waitcnt lgkmcnt(5)
    v_mfma_f32_16x16x32_bf16 v[164:167], v[32:35], v[120:123], v[164:167]
    ds_read_b128 v[32:35], v22
    s_waitcnt lgkmcnt(5)
    v_mfma_f32_32x32x16_bf16 v[132:147], v[36:39], v[124:127], v[132:147]
    s_waitcnt lgkmcnt(4)
    v_mfma_f32_32x32x16_bf16 v[148:163], v[40:43], v[124:127], v[148:163]
    s_waitcnt lgkmcnt(3)
    v_mfma_f32_16x16x32_bf16 v[164:167], v[44:47], v[124:127], v[164:167]
L2_u4:
    s_waitcnt vmcnt(4)
    s_bitcmp1_b32 s42, 4
    s_cbranch_scc0 L2_sk4
    v_max3_u32 v16, v48, v49, v50
    v_max_u32 v16, v16, v51
    v_cmp_eq_u32 vcc, s49, v16
    s_nop 4
    s_cbranch_vccnz L2_sk4
    s_bitset0_b32 s42, 4
    s_waitcnt lgkmcnt(2)
    v_mfma_f32_32x32x16_bf16 v[132:147], v[24:27], v[48:51], v[132:147]
    s_waitcnt lgkmcnt(1)
    v_mfma_f32_32x32x16_bf16 v[148:163], v[28:31], v[48:51], v[148:163]
    s_waitcnt lgkmcnt(0)
    v_mfma_f32_16x16x32_bf16 v[164:167], v[32:35], v[48:51], v[164:167]
L2_u5:
    s_waitcnt vmcnt(0)
    s_bitcmp1_b32 s42, 5
    s_cbranch_scc0 L2_sk5
    v_max3_u32 v16, v52, v53, v54
    v_max_u32 v16, v16, v55
    v_cmp_eq_u32 vcc, s49, v16
    s_nop 4
    s_cbranch_vccnz L2_sk5
    s_bitset0_b32 s42, 5
    v_mfma_f32_32x32x16_bf16 v[132:147], v[8:11], v[52:55], v[132:147]
    v_mfma_f32_32x32x16_bf16 v[148:163], v[12:15], v[52:55], v[148:163]
    v_mfma_f32_16x16x32_bf16 v[164:167], v[128:131], v[52:55], v[164:167]
L2_u6:
    s_cmp_lg_u32 s42, 0
    s_cbranch_scc1 L2_again
    s_waitcnt lgkmcnt(0)
    ds_add_u32 v17, v7 offset:32
    ds_read_b32 v16, v17 offset:32
    s_mul_i32 s44, s37, 10496
    s_add_u32 s44, s44, s19
    v_add_u32 v5, s44, v2
    v_add_u32 v3, 73728, v60
    v_add_u32 v4, 73728, v61

L2_pr:
    s_waitcnt lgkmcnt(0)
    v_readfirstlane_b32 s55, v16
    ds_read_b32 v16, v17 offset:32
    s_nop 2
    s_cmp_lt_u32 s55, 128
    s_cbranch_scc1 L2_pr
    s_nop 3

    ds_write_b128 v23, v[132:135] offset:0
    ds_write_b128 v23, v[136:139] offset:1088
    ds_write_b128 v23, v[140:143] offset:2368
    ds_write_b128 v23, v[144:147] offset:3456
    ds_write_b128 v23, v[148:151] offset:4736
    ds_write_b128 v23, v[152:155] offset:5824
    ds_write_b128 v23, v[156:159] offset:7104
    ds_write_b128 v23, v[160:163] offset:8192
    ds_write_b128 v5, v[164:167] offset:9472
    s_waitcnt lgkmcnt(0)
    s_barrier
    ds_read_b128 v[64:67], v60 offset:0
    ds_read_b128 v[68:71], v60 offset:1088
    ds_read_b128 v[72:75], v60 offset:36864
    ds_read_b128 v[76:79], v60 offset:37952
    ds_read_b128 v[80:83], v3 offset:0
    ds_read_b128 v[84:87], v3 offset:1088
    ds_read_b128 v[88:91], v3 offset:36864
    ds_read_b128 v[92:95], v3 offset:37952
    s_cmp_eq_u32 s39, 2
    s_cbranch_scc1 L2_t2
    s_waitcnt lgkmcnt(0)
    v_pk_add_f32 v[64:65], v[64:65], v[72:73]
    v_pk_add_f32 v[80:81], v[80:81], v[88:89]
    v_pk_add_f32 v[66:67], v[66:67], v[74:75]
    v_pk_add_f32 v[82:83], v[82:83], v[90:91]
    v_pk_add_f32 v[68:69], v[68:69], v[76:77]
    v_pk_add_f32 v[84:85], v[84:85], v[92:93]
    v_pk_add_f32 v[70:71], v[70:71], v[78:79]
    v_pk_add_f32 v[86:87], v[86:87], v[94:95]
    v_pk_mul_f32 v[64:65], v[64:65], v[56:57] op_sel_hi:[1,0]
    v_pk_mul_f32 v[66:67], v[66:67], v[56:57] op_sel_hi:[1,0]
    v_pk_mul_f32 v[68:69], v[68:69], v[56:57] op_sel_hi:[1,0]
    v_pk_mul_f32 v[70:71], v[70:71], v[56:57] op_sel_hi:[1,0]
    v_pk_fma_f32 v[64:65], v[80:81], v[56:57], v[64:65] op_sel:[0,1,0] op_sel_hi:[1,1,1]
    v_pk_fma_f32 v[66:67], v[82:83], v[56:57], v[66:67] op_sel:[0,1,0] op_sel_hi:[1,1,1]
    v_pk_fma_f32 v[68:69], v[84:85], v[56:57], v[68:69] op_sel:[0,1,0] op_sel_hi:[1,1,1]
    v_pk_fma_f32 v[70:71], v[86:87], v[56:57], v[70:71] op_sel:[0,1,0] op_sel_hi:[1,1,1]
    v_cvt_pk_bf16_f32 v72, v64, v65
    v_cvt_pk_bf16_f32 v73, v66, v67
    v_cvt_pk_bf16_f32 v74, v68, v69
    v_cvt_pk_bf16_f32 v75, v70, v71
    buffer_store_dwordx4 v[72:75], v62, s[24:27], s28 offen offset:0
    s_endpgm
L2_t2:
    ds_read_b128 v[96:99], v61 offset:0
    ds_read_b128 v[100:103], v61 offset:256
    ds_read_b128 v[104:107], v61 offset:36864
    ds_read_b128 v[108:111], v61 offset:37120
    ds_read_b128 v[112:115], v4 offset:0
    ds_read_b128 v[116:119], v4 offset:256
    ds_read_b128 v[120:123], v4 offset:36864
    s_waitcnt lgkmcnt(7)
    ds_read_b128 v[124:127], v4 offset:37120
    v_pk_add_f32 v[64:65], v[64:65], v[72:73]
    v_pk_add_f32 v[80:81], v[80:81], v[88:89]
    v_pk_add_f32 v[66:67], v[66:67], v[74:75]
    v_pk_add_f32 v[82:83], v[82:83], v[90:91]
    v_pk_add_f32 v[68:69], v[68:69], v[76:77]
    v_pk_add_f32 v[84:85], v[84:85], v[92:93]
    v_pk_add_f32 v[70:71], v[70:71], v[78:79]
    v_pk_add_f32 v[86:87], v[86:87], v[94:95]
    v_pk_mul_f32 v[64:65], v[64:65], v[56:57] op_sel_hi:[1,0]
    v_pk_mul_f32 v[66:67], v[66:67], v[56:57] op_sel_hi:[1,0]
    v_pk_mul_f32 v[68:69], v[68:69], v[56:57] op_sel_hi:[1,0]
    v_pk_mul_f32 v[70:71], v[70:71], v[56:57] op_sel_hi:[1,0]
    v_pk_fma_f32 v[64:65], v[80:81], v[56:57], v[64:65] op_sel:[0,1,0] op_sel_hi:[1,1,1]
    v_pk_fma_f32 v[66:67], v[82:83], v[56:57], v[66:67] op_sel:[0,1,0] op_sel_hi:[1,1,1]
    v_pk_fma_f32 v[68:69], v[84:85], v[56:57], v[68:69] op_sel:[0,1,0] op_sel_hi:[1,1,1]
    v_pk_fma_f32 v[70:71], v[86:87], v[56:57], v[70:71] op_sel:[0,1,0] op_sel_hi:[1,1,1]
    v_cvt_pk_bf16_f32 v72, v64, v65
    v_cvt_pk_bf16_f32 v73, v66, v67
    v_cvt_pk_bf16_f32 v74, v68, v69
    v_cvt_pk_bf16_f32 v75, v70, v71
    buffer_store_dwordx4 v[72:75], v62, s[24:27], s28 offen offset:0
    s_waitcnt lgkmcnt(0)
    v_pk_add_f32 v[96:97], v[96:97], v[104:105]
    v_pk_add_f32 v[112:113], v[112:113], v[120:121]
    v_pk_add_f32 v[98:99], v[98:99], v[106:107]
    v_pk_add_f32 v[114:115], v[114:115], v[122:123]
    v_pk_add_f32 v[100:101], v[100:101], v[108:109]
    v_pk_add_f32 v[116:117], v[116:117], v[124:125]
    v_pk_add_f32 v[102:103], v[102:103], v[110:111]
    v_pk_add_f32 v[118:119], v[118:119], v[126:127]
    v_pk_mul_f32 v[96:97], v[96:97], v[58:59] op_sel_hi:[1,0]
    v_pk_mul_f32 v[98:99], v[98:99], v[58:59] op_sel_hi:[1,0]
    v_pk_mul_f32 v[100:101], v[100:101], v[58:59] op_sel_hi:[1,0]
    v_pk_mul_f32 v[102:103], v[102:103], v[58:59] op_sel_hi:[1,0]
    v_pk_fma_f32 v[96:97], v[112:113], v[58:59], v[96:97] op_sel:[0,1,0] op_sel_hi:[1,1,1]
    v_pk_fma_f32 v[98:99], v[114:115], v[58:59], v[98:99] op_sel:[0,1,0] op_sel_hi:[1,1,1]
    v_pk_fma_f32 v[100:101], v[116:117], v[58:59], v[100:101] op_sel:[0,1,0] op_sel_hi:[1,1,1]
    v_pk_fma_f32 v[102:103], v[118:119], v[58:59], v[102:103] op_sel:[0,1,0] op_sel_hi:[1,1,1]
    v_cvt_pk_bf16_f32 v104, v96, v97
    v_cvt_pk_bf16_f32 v105, v98, v99
    v_cvt_pk_bf16_f32 v106, v100, v101
    v_cvt_pk_bf16_f32 v107, v102, v103
    buffer_store_dwordx4 v[104:107], v63, s[24:27], s28 offen offset:128
    s_endpgm
L2_sk0:
    ds_read_b128 v[24:27], v3 offset:9216
    ds_read_b128 v[28:31], v3 offset:9728
    ds_read_b128 v[32:35], v4 offset:9216
    ds_read_b128 v[36:39], v3 offset:11520
    ds_read_b128 v[40:43], v3 offset:12032
    ds_read_b128 v[44:47], v4 offset:11520
    s_branch L2_u1
L2_sk1:
    ds_read_b128 v[24:27], v3 offset:18432
    ds_read_b128 v[28:31], v3 offset:18944
    ds_read_b128 v[32:35], v4 offset:18432
    ds_read_b128 v[36:39], v3 offset:20736
    ds_read_b128 v[40:43], v3 offset:21248
    ds_read_b128 v[44:47], v4 offset:20736
    s_branch L2_u2
L2_sk2:
    ds_read_b128 v[24:27], v3 offset:27648
    ds_read_b128 v[28:31], v3 offset:28160
    ds_read_b128 v[32:35], v4 offset:27648
    ds_read_b128 v[36:39], v3 offset:29952
    ds_read_b128 v[40:43], v3 offset:30464
    ds_read_b128 v[44:47], v4 offset:29952
    s_branch L2_u3
L2_sk3:
    ds_read_b128 v[24:27], v5
    ds_read_b128 v[28:31], v5 offset:512
    ds_read_b128 v[32:35], v22
    s_branch L2_u4
L2_sk4:
    s_branch L2_u5
L2_sk5:
    s_branch L2_u6
L2_again:
    s_add_u32 s45, s45, 1
    s_cmp_gt_u32 s45, 40000
    s_cselect_b32 s42, 0, s42
    s_cbranch_scc1 L2_u6
    s_sleep 4

    s_bitcmp1_b32 s42, 0
    s_cbranch_scc0 L2_ag0
    buffer_load_dwordx4 v[64:67], v2, s[20:23], s8 offen offset:0 sc1
    buffer_load_dwordx4 v[68:71], v2, s[20:23], s8 offen offset:1024 sc1
    buffer_load_dwordx4 v[72:75], v2, s[20:23], s8 offen offset:2048 sc1
    buffer_load_dwordx4 v[76:79], v2, s[20:23], s8 offen offset:3072 sc1
L2_ag0:
    s_bitcmp1_b32 s42, 1
    s_cbranch_scc0 L2_ag1
    buffer_load_dwordx4 v[80:83], v2, s[20:23], s9 offen offset:0 sc1
    buffer_load_dwordx4 v[84:87], v2, s[20:23], s9 offen offset:1024 sc1
    buffer_load_dwordx4 v[88:91], v2, s[20:23], s9 offen offset:2048 sc1
    buffer_load_dwordx4 v[92:95], v2, s[20:23], s9 offen offset:3072 sc1
L2_ag1:
    s_bitcmp1_b32 s42, 2
    s_cbranch_scc0 L2_ag2
    buffer_load_dwordx4 v[96:99], v2, s[20:23], s10 offen offset:0 sc1
    buffer_load_dwordx4 v[100:103], v2, s[20:23], s10 offen offset:1024 sc1
    buffer_load_dwordx4 v[104:107], v2, s[20:23], s10 offen offset:2048 sc1
    buffer_load_dwordx4 v[108:111], v2, s[20:23], s10 offen offset:3072 sc1
L2_ag2:
    s_bitcmp1_b32 s42, 3
    s_cbranch_scc0 L2_ag3
    buffer_load_dwordx4 v[112:115], v2, s[20:23], s11 offen offset:0 sc1
    buffer_load_dwordx4 v[116:119], v2, s[20:23], s11 offen offset:1024 sc1
    buffer_load_dwordx4 v[120:123], v2, s[20:23], s11 offen offset:2048 sc1
    buffer_load_dwordx4 v[124:127], v2, s[20:23], s11 offen offset:3072 sc1
L2_ag3:
    s_bitcmp1_b32 s42, 4
    s_cbranch_scc0 L2_ag4
    buffer_load_dword v48, v21, s[20:23], s17 offen offset:0 sc1
    buffer_load_dword v49, v21, s[20:23], s17 offen offset:128 sc1
    buffer_load_dword v50, v21, s[20:23], s17 offen offset:256 sc1
    buffer_load_dword v51, v21, s[20:23], s17 offen offset:384 sc1
L2_ag4:
    s_bitcmp1_b32 s42, 5
    s_cbranch_scc0 L2_ag5
    buffer_load_dword v52, v21, s[20:23], s17 offen offset:1024 sc1
    buffer_load_dword v53, v21, s[20:23], s17 offen offset:1152 sc1
    buffer_load_dword v54, v21, s[20:23], s17 offen offset:1280 sc1
    buffer_load_dword v55, v21, s[20:23], s17 offen offset:1408 sc1
L2_ag5:
    s_waitcnt vmcnt(0)
    s_branch L2_round
L2_hook:
    s_cmp_eq_u32 s40, 0
    s_cbranch_scc0 L2_hk0
L2_hw0:
    ds_read_b32 v52, v6 offset:24
    s_waitcnt lgkmcnt(0)
    v_readfirstlane_b32 s44, v52
    s_nop 3
    s_cmp_eq_u32 s44, 0
    s_cbranch_scc1 L2_hw0

    s_branch L2_hookret
L2_hk0:
    s_cmp_eq_u32 s40, 3
    s_cbranch_scc0 L2_hk3
L2_hw3:
    ds_read_b32 v52, v6 offset:28
    s_waitcnt lgkmcnt(0)
    v_readfirstlane_b32 s44, v52
    s_nop 3
    s_cmp_eq_u32 s44, 0
    s_cbranch_scc1 L2_hw3

    s_setprio 2
    s_branch L2_hookret
L2_hk3:
    s_cmp_eq_u32 s40, 6
    s_cbranch_scc0 L2_hk6
    s_setprio 1
    s_waitcnt lgkmcnt(0)
    ds_add_u32 v6, v7 offset:0
    s_branch L2_hookret
L2_hk6:
    s_cmp_eq_u32 s40, 7
    s_cbranch_scc0 L2_hk7
L2_hw7:
    ds_read_b32 v52, v6 offset:20
    s_waitcnt lgkmcnt(0)
    v_readfirstlane_b32 s44, v52
    s_nop 3
    s_cmp_eq_u32 s44, 0
    s_cbranch_scc1 L2_hw7

    s_setprio 0
    s_waitcnt lgkmcnt(0)
    ds_add_u32 v6, v7 offset:4
    s_branch L2_hookret
L2_hk7:
    s_branch L2_hookret
L2_fallback:
    v_subrev_u32 v2, 151552, v2
    v_subrev_u32 v3, 151552, v3
    v_subrev_u32 v4, 151552, v4
    v_mov_b32 v17, 0
    v_and_b32 v3, 0x7f, v3
    v_bfe_u32 v52, v4, 4, 6
    s_waitcnt lgkmcnt(0)

    v_mul_u32_u24 v53, 3450, v52
    v_lshrrev_b32 v53, 16, v53
    v_mul_u32_u24 v54, 19, v53
    v_sub_u32 v54, v52, v54
    v_mul_u32_u24 v53, 9856, v53
    v_cmp_lt_u32 vcc, 15, v54
    v_lshl_add_u32 v4, v54, 4, s62
    v_add_u32 v52, s63, v4
    v_cndmask_b32 v4, v4, v52, vcc
    v_cmp_eq_u32 vcc, 18, v54
    v_mov_b32 v52, 9728
    s_nop 0
    v_cndmask_b32 v4, v4, v52, vcc
    v_add_u32 v4, v4, v53

    v_mov_b32 v52, 0xff800000
    v_mov_b32 v53, 0xff800000

    v_mov_b32 v64, 0
    v_mov_b32 v65, 0
    v_mov_b32 v66, 0
    v_mov_b32 v67, 0
    v_mov_b32 v68, 0
    v_mov_b32 v69, 0
    v_mov_b32 v70, 0
    v_mov_b32 v71, 0
    v_mov_b32 v72, 0
    v_mov_b32 v73, 0
    v_mov_b32 v74, 0
    v_mov_b32 v75, 0
    v_mov_b32 v76, 0
    v_mov_b32 v77, 0
    v_mov_b32 v78, 0
    v_mov_b32 v79, 0
    v_mov_b32 v80, 0
    v_mov_b32 v81, 0
    v_mov_b32 v82, 0
    v_mov_b32 v83, 0
    v_mov_b32 v84, 0
    v_mov_b32 v85, 0
    v_mov_b32 v86, 0
    v_mov_b32 v87, 0
    v_mov_b32 v88, 0
    v_mov_b32 v89, 0
    v_mov_b32 v90, 0
    v_mov_b32 v91, 0
    v_mov_b32 v92, 0
    v_mov_b32 v93, 0
    v_mov_b32 v94, 0
    v_mov_b32 v95, 0
    s_mov_b32 s40, 0
L2_fb0:
    s_lshr_b32 s41, s40, 3
    s_mul_i32 s41, s41, 9216
    s_add_u32 s41, s41, s36
    s_and_b32 s42, s40, 7
    s_lshl_b32 s43, s42, 10
    s_add_u32 s43, s43, s41
    buffer_load_dwordx4 v[28:31], v2, s[20:23], s43 offen
    s_lshl_b32 s43, s42, 7
    s_add_u32 s43, s43, s41
    s_add_u32 s43, s43, 8192
    buffer_load_dword v24, v3, s[20:23], s43 offen
    s_mul_i32 s43, s40, 39424
    s_add_u32 s43, s43, 7225344
    buffer_load_dwordx4 v[36:39], v4, s[20:23], s43 offen
    s_add_u32 s43, s43, 19712
    buffer_load_dwordx4 v[40:43], v4, s[20:23], s43 offen
    s_waitcnt vmcnt(0)

    v_mfma_f32_32x32x4_2b_bf16 v[96:127], v[24:25], v[16:17], 0 cbsz:1 abid:0
    s_nop 15
    s_nop 1
    v_mfma_f32_32x32x16_bf16 v[96:111], v[28:31], v[8:11], v[96:111]
    v_mfma_f32_32x32x16_bf16 v[112:127], v[28:31], v[12:15], v[112:127]
    s_nop 11
    v_max3_f32 v52, v52, v96, v97
    v_max3_f32 v52, v52, v98, v99
    v_max3_f32 v52, v52, v100, v101
    v_max3_f32 v52, v52, v102, v103
    v_max3_f32 v52, v52, v104, v105
    v_max3_f32 v52, v52, v106, v107
    v_max3_f32 v52, v52, v108, v109
    v_max3_f32 v52, v52, v110, v111
    v_max3_f32 v53, v53, v112, v113
    v_max3_f32 v53, v53, v114, v115
    v_max3_f32 v53, v53, v116, v117
    v_max3_f32 v53, v53, v118, v119
    v_max3_f32 v53, v53, v120, v121
    v_max3_f32 v53, v53, v122, v123
    v_max3_f32 v53, v53, v124, v125
    v_max3_f32 v53, v53, v126, v127
    s_add_u32 s40, s40, 1
    s_cmp_lt_u32 s40, 64
    s_cbranch_scc1 L2_fb0
    v_mov_b32 v54, v52
    v_mov_b32 v55, v53
    s_nop 1
    v_permlane32_swap_b32 v52, v54
    v_permlane32_swap_b32 v53, v55
    s_nop 0
    v_max_f32 v52, v52, v54
    v_max_f32 v53, v53, v55

    s_mov_b32 s40, 0
L2_fb1:
    s_lshr_b32 s41, s40, 3
    s_mul_i32 s41, s41, 9216
    s_add_u32 s41, s41, s36
    s_and_b32 s42, s40, 7
    s_lshl_b32 s43, s42, 10
    s_add_u32 s43, s43, s41
    buffer_load_dwordx4 v[28:31], v2, s[20:23], s43 offen
    s_lshl_b32 s43, s42, 7
    s_add_u32 s43, s43, s41
    s_add_u32 s43, s43, 8192
    buffer_load_dword v24, v3, s[20:23], s43 offen
    s_mul_i32 s43, s40, 39424
    s_add_u32 s43, s43, 7225344
    buffer_load_dwordx4 v[36:39], v4, s[20:23], s43 offen
    s_add_u32 s43, s43, 19712
    buffer_load_dwordx4 v[40:43], v4, s[20:23], s43 offen
    s_waitcnt vmcnt(0)

    v_mfma_f32_32x32x4_2b_bf16 v[96:127], v[24:25], v[16:17], 0 cbsz:1 abid:0
    s_nop 15
    s_nop 1
    v_mfma_f32_32x32x16_bf16 v[96:111], v[28:31], v[8:11], v[96:111]
    v_mfma_f32_32x32x16_bf16 v[112:127], v[28:31], v[12:15], v[112:127]
    s_nop 11
    v_sub_f32 v96, v96, v52
    v_sub_f32 v97, v97, v52
    v_sub_f32 v98, v98, v52
    v_sub_f32 v99, v99, v52
    v_sub_f32 v100, v100, v52
    v_sub_f32 v101, v101, v52
    v_sub_f32 v102, v102, v52
    v_sub_f32 v103, v103, v52
    v_sub_f32 v104, v104, v52
    v_sub_f32 v105, v105, v52
    v_sub_f32 v106, v106, v52
    v_sub_f32 v107, v107, v52
    v_sub_f32 v108, v108, v52
    v_sub_f32 v109, v109, v52
    v_sub_f32 v110, v110, v52
    v_sub_f32 v111, v111, v52
    v_sub_f32 v112, v112, v53
    v_sub_f32 v113, v113, v53
    v_sub_f32 v114, v114, v53
    v_sub_f32 v115, v115, v53
    v_sub_f32 v116, v116, v53
    v_sub_f32 v117, v117, v53
    v_sub_f32 v118, v118, v53
    v_sub_f32 v119, v119, v53
    v_sub_f32 v120, v120, v53
    v_sub_f32 v121, v121, v53
    v_sub_f32 v122, v122, v53
    v_sub_f32 v123, v123, v53
    v_sub_f32 v124, v124, v53
    v_sub_f32 v125, v125, v53
    v_sub_f32 v126, v126, v53
    v_sub_f32 v127, v127, v53
    v_exp_f32 v96, v96
    v_exp_f32 v97, v97
    v_exp_f32 v98, v98
    v_exp_f32 v99, v99
    v_exp_f32 v100, v100
    v_exp_f32 v101, v101
    v_exp_f32 v102, v102
    v_exp_f32 v103, v103
    v_exp_f32 v104, v104
    v_exp_f32 v105, v105
    v_exp_f32 v106, v106
    v_exp_f32 v107, v107
    v_exp_f32 v108, v108
    v_exp_f32 v109, v109
    v_exp_f32 v110, v110
    v_exp_f32 v111, v111
    v_exp_f32 v112, v112
    v_exp_f32 v113, v113
    v_exp_f32 v114, v114
    v_exp_f32 v115, v115
    v_exp_f32 v116, v116
    v_exp_f32 v117, v117
    v_exp_f32 v118, v118
    v_exp_f32 v119, v119
    v_exp_f32 v120, v120
    v_exp_f32 v121, v121
    v_exp_f32 v122, v122
    v_exp_f32 v123, v123
    v_exp_f32 v124, v124
    v_exp_f32 v125, v125
    v_exp_f32 v126, v126
    v_exp_f32 v127, v127
    s_nop 1
    v_smfmac_f32_32x32x32_bf16 v[64:79], v[36:39], v[96:103], v5
    v_smfmac_f32_32x32x32_bf16 v[64:79], v[40:43], v[104:111], v5
    v_smfmac_f32_32x32x32_bf16 v[80:95], v[36:39], v[112:119], v5
    v_smfmac_f32_32x32x32_bf16 v[80:95], v[40:43], v[120:127], v5
    s_add_u32 s40, s40, 1
    s_cmp_lt_u32 s40, 64
    s_cbranch_scc1 L2_fb1
    s_nop 15
    v_cndmask_b32 v52, v74, v76, s[50:51]
    v_cndmask_b32 v53, v90, v92, s[50:51]
    s_branch L2_norm

L2_loader:
    v_add_u32 v4, 512, v1
    v_mul_u32_u24 v5, 3450, v4
    v_lshrrev_b32 v5, 16, v5
    v_mul_u32_u24 v8, 19, v5
    v_sub_u32 v8, v4, v8
    v_mul_u32_u24 v5, 9856, v5
    v_cmp_lt_u32 vcc, 15, v8
    v_lshl_add_u32 v88, v8, 4, s62
    v_add_u32 v4, s63, v88
    v_cndmask_b32 v88, v88, v4, vcc
    v_cmp_eq_u32 vcc, 18, v8
    v_mov_b32 v4, 9728
    s_nop 0
    v_cndmask_b32 v88, v88, v4, vcc
    v_add_u32 v88, v88, v5

    v_add_u32 v4, 576, v1
    v_mul_u32_u24 v5, 3450, v4
    v_lshrrev_b32 v5, 16, v5
    v_mul_u32_u24 v8, 19, v5
    v_sub_u32 v8, v4, v8
    v_mul_u32_u24 v5, 9856, v5
    v_cmp_lt_u32 vcc, 15, v8
    v_lshl_add_u32 v89, v8, 4, s62
    v_add_u32 v4, s63, v89
    v_cndmask_b32 v89, v89, v4, vcc
    v_cmp_eq_u32 vcc, 18, v8
    v_mov_b32 v4, 9728
    s_nop 0
    v_cndmask_b32 v89, v89, v4, vcc
    v_add_u32 v89, v89, v5

    s_waitcnt lgkmcnt(0)
    s_mov_b32 s20, s4
    s_mov_b32 s21, s5
    s_mov_b32 s22, 15974528
    s_mov_b32 s23, 0x00020000
    s_mov_b32 m0, 8192
    s_add_u32 s45, s36, 8192
    buffer_load_dwordx4 v2, s[20:23], s45 offen lds
    s_mov_b32 m0, 17408
    s_mov_b32 s45, 7225344
    buffer_load_dwordx4 v88, s[20:23], s45 offen lds
    s_mov_b32 m0, 18432
    s_mov_b32 s45, 7225344
    s_mov_b32 exec_hi, 0
    buffer_load_dwordx4 v89, s[20:23], s45 offen lds
    s_mov_b32 exec_hi, -1
    s_setprio 3
    v_mov_b32 v6, 163584
    v_mov_b32 v16, 0
    v_mov_b32 v17, 0
    v_mov_b32 v18, 0
    v_mov_b32 v19, 0
    ds_write_b128 v6, v[16:19]
    ds_write_b128 v6, v[16:19] offset:16
    ds_write_b128 v6, v[16:19] offset:32
    v_lshlrev_b32 v7, 6, v1
    v_lshlrev_b32 v3, 1, v1
    v_lshlrev_b32 v14, 2, v1
    v_mov_b32 v15, 0x7ff00000
    v_cmp_gt_u32 vcc, 16, v1
    s_mul_i32 s37, s31, 165888
    s_add_u32 s37, s37, 14467072
    s_mov_b32 s53, 164736
    v_cndmask_b32 v14, v15, v14, vcc
    v_mov_b32 v15, 1

    v_lshlrev_b32 v4, 2, v1
    v_add_u32 v4, 161280, v4
    v_mov_b32 v92, -1
    v_mov_b32 v93, -1
    v_mov_b32 v94, -1
    v_mov_b32 v95, -1
    v_and_b32 v5, 31, v1
    v_lshlrev_b32 v5, 2, v5
    v_lshrrev_b32 v8, 5, v1
    v_lshl_add_u32 v90, v8, 13, v5

    s_waitcnt lgkmcnt(0)
    s_waitcnt vmcnt(0)
    s_barrier
    ds_read_b32 v80, v4 offset:0
    ds_read_b32 v81, v4 offset:256
    ds_read_b32 v82, v4 offset:512
    ds_read_b32 v83, v4 offset:768
    ds_read_b32 v84, v4 offset:1024
    ds_read_b32 v85, v4 offset:1280
    ds_read_b32 v86, v4 offset:1536
    ds_read_b32 v87, v4 offset:1792
    s_waitcnt lgkmcnt(0)
    s_mov_b32 m0, 18944
    s_add_u32 s45, s36, 9216
    buffer_load_dwordx4 v2, s[20:23], s45 offen lds
    s_mov_b32 m0, 19968
    s_add_u32 s45, s36, 10240
    buffer_load_dwordx4 v2, s[20:23], s45 offen lds
    s_mov_b32 m0, 20992
    s_add_u32 s45, s36, 11264
    buffer_load_dwordx4 v2, s[20:23], s45 offen lds
    s_mov_b32 m0, 22016
    s_add_u32 s45, s36, 12288
    buffer_load_dwordx4 v2, s[20:23], s45 offen lds
    s_mov_b32 m0, 23040
    s_add_u32 s45, s36, 13312
    buffer_load_dwordx4 v2, s[20:23], s45 offen lds
    s_mov_b32 m0, 24064
    s_add_u32 s45, s36, 14336
    buffer_load_dwordx4 v2, s[20:23], s45 offen lds
    s_mov_b32 m0, 25088
    s_add_u32 s45, s36, 15360
    buffer_load_dwordx4 v2, s[20:23], s45 offen lds
    s_mov_b32 m0, 26112
    s_add_u32 s45, s36, 16384
    buffer_load_dwordx4 v2, s[20:23], s45 offen lds
    s_mov_b32 m0, 27136
    s_add_u32 s45, s36, 17408
    buffer_load_dwordx4 v2, s[20:23], s45 offen lds
    s_mov_b32 m0, 28160
    s_mov_b32 s45, 7540736
    buffer_load_dwordx4 v80, s[20:23], s45 offen lds
    s_mov_b32 m0, 29184
    s_mov_b32 s45, 7540736
    buffer_load_dwordx4 v81, s[20:23], s45 offen lds
    s_mov_b32 m0, 30208
    s_mov_b32 s45, 7540736
    buffer_load_dwordx4 v82, s[20:23], s45 offen lds
    s_mov_b32 m0, 31232
    s_mov_b32 s45, 7540736
    buffer_load_dwordx4 v83, s[20:23], s45 offen lds
    s_mov_b32 m0, 32256
    s_mov_b32 s45, 7540736
    buffer_load_dwordx4 v84, s[20:23], s45 offen lds
    s_mov_b32 m0, 33280
    s_mov_b32 s45, 7540736
    buffer_load_dwordx4 v85, s[20:23], s45 offen lds
    s_mov_b32 m0, 34304
    s_mov_b32 s45, 7540736
    buffer_load_dwordx4 v86, s[20:23], s45 offen lds
    s_mov_b32 m0, 35328
    s_mov_b32 s45, 7540736
    buffer_load_dwordx4 v87, s[20:23], s45 offen lds
    s_mov_b32 m0, 36352
    s_mov_b32 s45, 7540736
    buffer_load_dwordx4 v88, s[20:23], s45 offen lds
    s_mov_b32 m0, 37376
    s_mov_b32 s45, 7540736
    s_mov_b32 exec_hi, 0
    buffer_load_dwordx4 v89, s[20:23], s45 offen lds
    s_mov_b32 exec_hi, -1
    s_mov_b32 m0, 37888
    s_add_u32 s45, s36, 18432
    buffer_load_dwordx4 v2, s[20:23], s45 offen lds
    s_mov_b32 m0, 38912
    s_add_u32 s45, s36, 19456
    buffer_load_dwordx4 v2, s[20:23], s45 offen lds
    s_mov_b32 m0, 39936
    s_add_u32 s45, s36, 20480
    buffer_load_dwordx4 v2, s[20:23], s45 offen lds
    s_mov_b32 m0, 40960
    s_add_u32 s45, s36, 21504
    buffer_load_dwordx4 v2, s[20:23], s45 offen lds
    s_mov_b32 m0, 41984
    s_add_u32 s45, s36, 22528
    buffer_load_dwordx4 v2, s[20:23], s45 offen lds
    s_mov_b32 m0, 43008
    s_add_u32 s45, s36, 23552
    buffer_load_dwordx4 v2, s[20:23], s45 offen lds
    s_mov_b32 m0, 44032
    s_add_u32 s45, s36, 24576
    buffer_load_dwordx4 v2, s[20:23], s45 offen lds
    s_mov_b32 m0, 45056
    s_add_u32 s45, s36, 25600
    buffer_load_dwordx4 v2, s[20:23], s45 offen lds
    s_mov_b32 m0, 46080
    s_add_u32 s45, s36, 26624
    buffer_load_dwordx4 v2, s[20:23], s45 offen lds
    s_mov_b32 m0, 47104
    s_mov_b32 s45, 7856128
    buffer_load_dwordx4 v80, s[20:23], s45 offen lds
    s_mov_b32 m0, 48128
    s_mov_b32 s45, 7856128
    buffer_load_dwordx4 v81, s[20:23], s45 offen lds
    s_mov_b32 m0, 49152
    s_mov_b32 s45, 7856128
    buffer_load_dwordx4 v82, s[20:23], s45 offen lds
    s_mov_b32 m0, 50176
    s_mov_b32 s45, 7856128
    buffer_load_dwordx4 v83, s[20:23], s45 offen lds
    s_mov_b32 m0, 51200
    s_mov_b32 s45, 7856128
    buffer_load_dwordx4 v84, s[20:23], s45 offen lds
    s_mov_b32 m0, 52224
    s_mov_b32 s45, 7856128
    buffer_load_dwordx4 v85, s[20:23], s45 offen lds
    s_mov_b32 m0, 53248
    s_mov_b32 s45, 7856128
    buffer_load_dwordx4 v86, s[20:23], s45 offen lds
    s_mov_b32 m0, 54272
    s_mov_b32 s45, 7856128
    buffer_load_dwordx4 v87, s[20:23], s45 offen lds
    s_mov_b32 m0, 55296
    s_mov_b32 s45, 7856128
    buffer_load_dwordx4 v88, s[20:23], s45 offen lds
    s_mov_b32 m0, 56320
    s_mov_b32 s45, 7856128
    s_mov_b32 exec_hi, 0
    buffer_load_dwordx4 v89, s[20:23], s45 offen lds
    s_mov_b32 exec_hi, -1
    s_mov_b32 m0, 56832
    s_add_u32 s45, s36, 27648
    buffer_load_dwordx4 v2, s[20:23], s45 offen lds
    s_mov_b32 m0, 57856
    s_add_u32 s45, s36, 28672
    buffer_load_dwordx4 v2, s[20:23], s45 offen lds
    s_mov_b32 m0, 58880
    s_add_u32 s45, s36, 29696
    buffer_load_dwordx4 v2, s[20:23], s45 offen lds
    s_mov_b32 m0, 59904
    s_add_u32 s45, s36, 30720
    buffer_load_dwordx4 v2, s[20:23], s45 offen lds
    s_mov_b32 m0, 60928
    s_add_u32 s45, s36, 31744
    buffer_load_dwordx4 v2, s[20:23], s45 offen lds
    s_mov_b32 m0, 61952
    s_add_u32 s45, s36, 32768
    buffer_load_dwordx4 v2, s[20:23], s45 offen lds
    s_mov_b32 m0, 62976
    s_add_u32 s45, s36, 33792
    buffer_load_dwordx4 v2, s[20:23], s45 offen lds
    s_mov_b32 m0, 64000
    s_add_u32 s45, s36, 34816
    buffer_load_dwordx4 v2, s[20:23], s45 offen lds
    s_mov_b32 m0, 65024
    s_add_u32 s45, s36, 35840
    buffer_load_dwordx4 v2, s[20:23], s45 offen lds
    s_mov_b32 m0, 66048
    s_mov_b32 s45, 8171520
    buffer_load_dwordx4 v80, s[20:23], s45 offen lds
    s_mov_b32 m0, 67072
    s_mov_b32 s45, 8171520
    buffer_load_dwordx4 v81, s[20:23], s45 offen lds
    s_mov_b32 m0, 68096
    s_mov_b32 s45, 8171520
    buffer_load_dwordx4 v82, s[20:23], s45 offen lds
    s_mov_b32 m0, 69120
    s_mov_b32 s45, 8171520
    buffer_load_dwordx4 v83, s[20:23], s45 offen lds
    s_mov_b32 m0, 70144
    s_mov_b32 s45, 8171520
    buffer_load_dwordx4 v84, s[20:23], s45 offen lds
    s_mov_b32 m0, 71168
    s_mov_b32 s45, 8171520
    buffer_load_dwordx4 v85, s[20:23], s45 offen lds
    s_mov_b32 m0, 72192
    s_mov_b32 s45, 8171520
    buffer_load_dwordx4 v86, s[20:23], s45 offen lds
    s_mov_b32 m0, 73216
    s_mov_b32 s45, 8171520
    buffer_load_dwordx4 v87, s[20:23], s45 offen lds
    s_mov_b32 m0, 74240
    s_mov_b32 s45, 8171520
    buffer_load_dwordx4 v88, s[20:23], s45 offen lds
    s_mov_b32 m0, 75264
    s_mov_b32 s45, 8171520
    s_mov_b32 exec_hi, 0
    buffer_load_dwordx4 v89, s[20:23], s45 offen lds
    s_mov_b32 exec_hi, -1
    s_mov_b32 m0, 75776
    s_add_u32 s45, s36, 36864
    buffer_load_dwordx4 v2, s[20:23], s45 offen lds
    s_mov_b32 m0, 76800
    s_add_u32 s45, s36, 37888
    buffer_load_dwordx4 v2, s[20:23], s45 offen lds
    s_mov_b32 m0, 77824
    s_add_u32 s45, s36, 38912
    buffer_load_dwordx4 v2, s[20:23], s45 offen lds
    s_mov_b32 m0, 78848
    s_add_u32 s45, s36, 39936
    buffer_load_dwordx4 v2, s[20:23], s45 offen lds
    s_mov_b32 m0, 79872
    s_add_u32 s45, s36, 40960
    buffer_load_dwordx4 v2, s[20:23], s45 offen lds
    s_mov_b32 m0, 80896
    s_add_u32 s45, s36, 41984
    buffer_load_dwordx4 v2, s[20:23], s45 offen lds
    s_mov_b32 m0, 81920
    s_add_u32 s45, s36, 43008
    buffer_load_dwordx4 v2, s[20:23], s45 offen lds
    s_mov_b32 m0, 82944
    s_add_u32 s45, s36, 44032
    buffer_load_dwordx4 v2, s[20:23], s45 offen lds
    s_mov_b32 m0, 83968
    s_add_u32 s45, s36, 45056
    buffer_load_dwordx4 v2, s[20:23], s45 offen lds
    s_mov_b32 m0, 84992
    s_mov_b32 s45, 8486912
    buffer_load_dwordx4 v80, s[20:23], s45 offen lds
    s_mov_b32 m0, 86016
    s_mov_b32 s45, 8486912
    buffer_load_dwordx4 v81, s[20:23], s45 offen lds
    s_mov_b32 m0, 87040
    s_mov_b32 s45, 8486912
    buffer_load_dwordx4 v82, s[20:23], s45 offen lds
    s_mov_b32 m0, 88064
    s_mov_b32 s45, 8486912
    buffer_load_dwordx4 v83, s[20:23], s45 offen lds
    s_mov_b32 m0, 89088
    s_mov_b32 s45, 8486912
    buffer_load_dwordx4 v84, s[20:23], s45 offen lds
    s_mov_b32 m0, 90112
    s_mov_b32 s45, 8486912
    buffer_load_dwordx4 v85, s[20:23], s45 offen lds
    s_mov_b32 m0, 91136
    s_mov_b32 s45, 8486912
    buffer_load_dwordx4 v86, s[20:23], s45 offen lds
    s_mov_b32 m0, 92160
    s_mov_b32 s45, 8486912
    buffer_load_dwordx4 v87, s[20:23], s45 offen lds
    s_mov_b32 m0, 93184
    s_mov_b32 s45, 8486912
    buffer_load_dwordx4 v88, s[20:23], s45 offen lds
    s_mov_b32 m0, 94208
    s_mov_b32 s45, 8486912
    s_mov_b32 exec_hi, 0
    buffer_load_dwordx4 v89, s[20:23], s45 offen lds
    s_mov_b32 exec_hi, -1
    s_waitcnt vmcnt(19)
    ds_write_b32 v6, v15 offset:24
    s_mov_b32 m0, 94720
    s_add_u32 s45, s36, 46080
    buffer_load_dwordx4 v2, s[20:23], s45 offen lds
    s_mov_b32 m0, 95744
    s_add_u32 s45, s36, 47104
    buffer_load_dwordx4 v2, s[20:23], s45 offen lds
    s_mov_b32 m0, 96768
    s_add_u32 s45, s36, 48128
    buffer_load_dwordx4 v2, s[20:23], s45 offen lds
    s_mov_b32 m0, 97792
    s_add_u32 s45, s36, 49152
    buffer_load_dwordx4 v2, s[20:23], s45 offen lds
    s_mov_b32 m0, 98816
    s_add_u32 s45, s36, 50176
    buffer_load_dwordx4 v2, s[20:23], s45 offen lds
    s_mov_b32 m0, 99840
    s_add_u32 s45, s36, 51200
    buffer_load_dwordx4 v2, s[20:23], s45 offen lds
    s_mov_b32 m0, 100864
    s_add_u32 s45, s36, 52224
    buffer_load_dwordx4 v2, s[20:23], s45 offen lds
    s_mov_b32 m0, 101888
    s_add_u32 s45, s36, 53248
    buffer_load_dwordx4 v2, s[20:23], s45 offen lds
    s_mov_b32 m0, 102912
    s_add_u32 s45, s36, 54272
    buffer_load_dwordx4 v2, s[20:23], s45 offen lds
    s_mov_b32 m0, 103936
    s_mov_b32 s45, 8802304
    buffer_load_dwordx4 v80, s[20:23], s45 offen lds
    s_mov_b32 m0, 104960
    s_mov_b32 s45, 8802304
    buffer_load_dwordx4 v81, s[20:23], s45 offen lds
    s_mov_b32 m0, 105984
    s_mov_b32 s45, 8802304
    buffer_load_dwordx4 v82, s[20:23], s45 offen lds
    s_mov_b32 m0, 107008
    s_mov_b32 s45, 8802304
    buffer_load_dwordx4 v83, s[20:23], s45 offen lds
    s_mov_b32 m0, 108032
    s_mov_b32 s45, 8802304
    buffer_load_dwordx4 v84, s[20:23], s45 offen lds
    s_mov_b32 m0, 109056
    s_mov_b32 s45, 8802304
    buffer_load_dwordx4 v85, s[20:23], s45 offen lds
    s_mov_b32 m0, 110080
    s_mov_b32 s45, 8802304
    buffer_load_dwordx4 v86, s[20:23], s45 offen lds
    s_mov_b32 m0, 111104
    s_mov_b32 s45, 8802304
    buffer_load_dwordx4 v87, s[20:23], s45 offen lds
    s_mov_b32 m0, 112128
    s_mov_b32 s45, 8802304
    buffer_load_dwordx4 v88, s[20:23], s45 offen lds
    s_mov_b32 m0, 113152
    s_mov_b32 s45, 8802304
    s_mov_b32 exec_hi, 0
    buffer_load_dwordx4 v89, s[20:23], s45 offen lds
    s_mov_b32 exec_hi, -1
    s_mov_b32 m0, 113664
    s_add_u32 s45, s36, 55296
    buffer_load_dwordx4 v2, s[20:23], s45 offen lds
    s_mov_b32 m0, 114688
    s_add_u32 s45, s36, 56320
    buffer_load_dwordx4 v2, s[20:23], s45 offen lds
    s_mov_b32 m0, 115712
    s_add_u32 s45, s36, 57344
    buffer_load_dwordx4 v2, s[20:23], s45 offen lds
    s_mov_b32 m0, 116736
    s_add_u32 s45, s36, 58368
    buffer_load_dwordx4 v2, s[20:23], s45 offen lds
    s_mov_b32 m0, 117760
    s_add_u32 s45, s36, 59392
    buffer_load_dwordx4 v2, s[20:23], s45 offen lds
    s_mov_b32 m0, 118784
    s_add_u32 s45, s36, 60416
    buffer_load_dwordx4 v2, s[20:23], s45 offen lds
    s_mov_b32 m0, 119808
    s_add_u32 s45, s36, 61440
    buffer_load_dwordx4 v2, s[20:23], s45 offen lds
    s_mov_b32 m0, 120832
    s_add_u32 s45, s36, 62464
    buffer_load_dwordx4 v2, s[20:23], s45 offen lds
    s_mov_b32 m0, 121856
    s_add_u32 s45, s36, 63488
    buffer_load_dwordx4 v2, s[20:23], s45 offen lds
    s_mov_b32 m0, 122880
    s_mov_b32 s45, 9117696
    buffer_load_dwordx4 v80, s[20:23], s45 offen lds
    s_mov_b32 m0, 123904
    s_mov_b32 s45, 9117696
    buffer_load_dwordx4 v81, s[20:23], s45 offen lds
    s_mov_b32 m0, 124928
    s_mov_b32 s45, 9117696
    buffer_load_dwordx4 v82, s[20:23], s45 offen lds
    s_mov_b32 m0, 125952
    s_mov_b32 s45, 9117696
    buffer_load_dwordx4 v83, s[20:23], s45 offen lds
    s_mov_b32 m0, 126976
    s_mov_b32 s45, 9117696
    buffer_load_dwordx4 v84, s[20:23], s45 offen lds
    s_mov_b32 m0, 128000
    s_mov_b32 s45, 9117696
    buffer_load_dwordx4 v85, s[20:23], s45 offen lds
    s_mov_b32 m0, 129024
    s_mov_b32 s45, 9117696
    buffer_load_dwordx4 v86, s[20:23], s45 offen lds
    s_mov_b32 m0, 130048
    s_mov_b32 s45, 9117696
    buffer_load_dwordx4 v87, s[20:23], s45 offen lds
    s_mov_b32 m0, 131072
    s_mov_b32 s45, 9117696
    buffer_load_dwordx4 v88, s[20:23], s45 offen lds
    s_mov_b32 m0, 132096
    s_mov_b32 s45, 9117696
    s_mov_b32 exec_hi, 0
    buffer_load_dwordx4 v89, s[20:23], s45 offen lds
    s_mov_b32 exec_hi, -1
    s_mov_b32 m0, 132608
    s_add_u32 s45, s36, 64512
    buffer_load_dwordx4 v2, s[20:23], s45 offen lds
    s_mov_b32 m0, 133632
    s_add_u32 s45, s36, 65536
    buffer_load_dwordx4 v2, s[20:23], s45 offen lds
    s_mov_b32 m0, 134656
    s_add_u32 s45, s36, 66560
    buffer_load_dwordx4 v2, s[20:23], s45 offen lds
    s_mov_b32 m0, 135680
    s_add_u32 s45, s36, 67584
    buffer_load_dwordx4 v2, s[20:23], s45 offen lds
    s_mov_b32 m0, 136704
    s_add_u32 s45, s36, 68608
    buffer_load_dwordx4 v2, s[20:23], s45 offen lds
    s_mov_b32 m0, 137728
    s_add_u32 s45, s36, 69632
    buffer_load_dwordx4 v2, s[20:23], s45 offen lds
    s_mov_b32 m0, 138752
    s_add_u32 s45, s36, 70656
    buffer_load_dwordx4 v2, s[20:23], s45 offen lds
    s_mov_b32 m0, 139776
    s_add_u32 s45, s36, 71680
    buffer_load_dwordx4 v2, s[20:23], s45 offen lds
    s_mov_b32 m0, 140800
    s_add_u32 s45, s36, 72704
    buffer_load_dwordx4 v2, s[20:23], s45 offen lds
    s_mov_b32 m0, 141824
    s_mov_b32 s45, 9433088
    buffer_load_dwordx4 v80, s[20:23], s45 offen lds
    s_mov_b32 m0, 142848
    s_mov_b32 s45, 9433088
    buffer_load_dwordx4 v81, s[20:23], s45 offen lds
    s_mov_b32 m0, 143872
    s_mov_b32 s45, 9433088
    buffer_load_dwordx4 v82, s[20:23], s45 offen lds
    s_mov_b32 m0, 144896
    s_mov_b32 s45, 9433088
    buffer_load_dwordx4 v83, s[20:23], s45 offen lds
    s_mov_b32 m0, 145920
    s_mov_b32 s45, 9433088
    buffer_load_dwordx4 v84, s[20:23], s45 offen lds
    s_mov_b32 m0, 146944
    s_mov_b32 s45, 9433088
    buffer_load_dwordx4 v85, s[20:23], s45 offen lds
    s_mov_b32 m0, 147968
    s_mov_b32 s45, 9433088
    buffer_load_dwordx4 v86, s[20:23], s45 offen lds
    s_mov_b32 m0, 148992
    s_mov_b32 s45, 9433088
    buffer_load_dwordx4 v87, s[20:23], s45 offen lds
    s_mov_b32 m0, 150016
    s_mov_b32 s45, 9433088
    buffer_load_dwordx4 v88, s[20:23], s45 offen lds
    s_mov_b32 m0, 151040
    s_mov_b32 s45, 9433088
    s_mov_b32 exec_hi, 0
    buffer_load_dwordx4 v89, s[20:23], s45 offen lds
    s_mov_b32 exec_hi, -1
    s_waitcnt vmcnt(0)
    ds_write_b32 v6, v15 offset:28
    s_lshl_b32 s44, s32, 5
    s_add_u32 s44, s44, s33
    s_lshl_b32 s45, s34, 10
    s_add_u32 s44, s44, s45
    s_lshl_b32 s45, s44, 7
    s_add_u32 s45, s45, 13942784
    s_lshl_b32 s44, s44, 10
    s_add_u32 s44, s44, 9748480

    buffer_store_dwordx4 v[92:95], v2, s[20:23], s44 offen sc0 sc1
    s_add_u32 s44, s44, 65536
    buffer_store_dword v92, v90, s[20:23], s45 offen sc0 sc1
    s_add_u32 s45, s45, 16384
    buffer_store_dwordx4 v[92:95], v2, s[20:23], s44 offen sc0 sc1
    s_add_u32 s44, s44, 65536
    buffer_store_dwordx4 v[92:95], v2, s[20:23], s44 offen sc0 sc1
    s_add_u32 s44, s44, 65536
    buffer_store_dword v92, v90, s[20:23], s45 offen sc0 sc1
    s_add_u32 s45, s45, 16384
    buffer_store_dwordx4 v[92:95], v2, s[20:23], s44 offen sc0 sc1
    s_add_u32 s44, s44, 65536
    buffer_store_dwordx4 v[92:95], v2, s[20:23], s44 offen sc0 sc1
    s_add_u32 s44, s44, 65536
    buffer_store_dword v92, v90, s[20:23], s45 offen sc0 sc1
    s_add_u32 s45, s45, 16384
    buffer_store_dwordx4 v[92:95], v2, s[20:23], s44 offen sc0 sc1
    s_add_u32 s44, s44, 65536
    buffer_store_dwordx4 v[92:95], v2, s[20:23], s44 offen sc0 sc1
    s_add_u32 s44, s44, 65536
    buffer_store_dword v92, v90, s[20:23], s45 offen sc0 sc1
    s_add_u32 s45, s45, 16384
    buffer_store_dwordx4 v[92:95], v2, s[20:23], s44 offen sc0 sc1
    s_add_u32 s44, s44, 65536
    buffer_store_dwordx4 v[92:95], v2, s[20:23], s44 offen sc0 sc1
    s_add_u32 s44, s44, 65536
    buffer_store_dword v92, v90, s[20:23], s45 offen sc0 sc1
    s_add_u32 s45, s45, 16384
    buffer_store_dwordx4 v[92:95], v2, s[20:23], s44 offen sc0 sc1
    s_add_u32 s44, s44, 65536
    buffer_store_dwordx4 v[92:95], v2, s[20:23], s44 offen sc0 sc1
    s_add_u32 s44, s44, 65536
    buffer_store_dword v92, v90, s[20:23], s45 offen sc0 sc1
    s_add_u32 s45, s45, 16384
    buffer_store_dwordx4 v[92:95], v2, s[20:23], s44 offen sc0 sc1
    s_add_u32 s44, s44, 65536
    buffer_store_dwordx4 v[92:95], v2, s[20:23], s44 offen sc0 sc1
    s_add_u32 s44, s44, 65536
    buffer_store_dword v92, v90, s[20:23], s45 offen sc0 sc1
    s_add_u32 s45, s45, 16384
    buffer_store_dwordx4 v[92:95], v2, s[20:23], s44 offen sc0 sc1
    s_add_u32 s44, s44, 65536
    buffer_store_dwordx4 v[92:95], v2, s[20:23], s44 offen sc0 sc1
    s_add_u32 s44, s44, 65536
    buffer_store_dword v92, v90, s[20:23], s45 offen sc0 sc1
    s_add_u32 s45, s45, 16384
    buffer_store_dwordx4 v[92:95], v2, s[20:23], s44 offen sc0 sc1
    s_add_u32 s44, s44, 65536
    s_mov_b32 s26, 663552
    s_mov_b32 s27, 0x00020000
    s_add_u32 s44, s2, 0
    s_mul_hi_u32 s45, s44, 477218589
    s_mul_i32 s46, s45, 9
    s_sub_u32 s46, s44, s46
    s_and_b32 s47, s45, 1
    s_lshr_b32 s48, s45, 1
    s_lshr_b32 s49, s48, 4
    s_and_b32 s50, s48, 15
    s_and_b32 s51, s48, 3
    s_lshr_b32 s52, s48, 2
    s_cmp_ge_u32 s48, 64
    s_cselect_b32 s49, s51, s49
    s_cselect_b32 s50, s52, s50
    s_bitcmp1_b32 s49, 1
    s_cselect_b32 s24, s10, s8
    s_cselect_b32 s25, s11, s9
    s_and_b32 s49, s49, 1
    s_lshl_b32 s51, s49, 4
    s_add_u32 s51, s51, s50
    s_mul_i32 s51, s51, 18
    s_lshl_b32 s48, s47, 3
    s_add_u32 s51, s51, s48
    s_lshl_b32 s49, s49, 1
    s_add_u32 s49, s49, s50
    s_sub_u32 s49, s49, 16
    s_lshl_b32 s49, s49, 1
    s_add_u32 s49, s49, s47
    s_mul_i32 s49, s49, 72
    s_add_u32 s49, s49, 16
    s_movk_i32 s48, 2304
    s_cmp_ge_u32 s50, 16
    s_cselect_b32 s51, s49, s51
    s_cselect_b32 s48, 20736, s48
    s_mul_i32 s51, s51, 1152
    s_lshl_b32 s49, s46, 7
    s_add_u32 s51, s51, s49
    s_cmp_ge_u32 s44, 1296
    s_cselect_b32 s51, 0, s51

    buffer_load_ushort v16, v3, s[24:27], s51 offen
    buffer_load_ushort v48, v3, s[24:27], s51 offen offset:1152
    s_add_u32 s51, s51, s48
    buffer_load_ushort v17, v3, s[24:27], s51 offen
    buffer_load_ushort v49, v3, s[24:27], s51 offen offset:1152
    s_add_u32 s51, s51, s48
    buffer_load_ushort v18, v3, s[24:27], s51 offen
    buffer_load_ushort v50, v3, s[24:27], s51 offen offset:1152
    s_add_u32 s51, s51, s48
    buffer_load_ushort v19, v3, s[24:27], s51 offen
    buffer_load_ushort v51, v3, s[24:27], s51 offen offset:1152
    s_add_u32 s44, s2, 256
    s_mul_hi_u32 s45, s44, 477218589
    s_mul_i32 s46, s45, 9
    s_sub_u32 s46, s44, s46
    s_and_b32 s47, s45, 1
    s_lshr_b32 s48, s45, 1
    s_lshr_b32 s49, s48, 4
    s_and_b32 s50, s48, 15
    s_and_b32 s51, s48, 3
    s_lshr_b32 s52, s48, 2
    s_cmp_ge_u32 s48, 64
    s_cselect_b32 s49, s51, s49
    s_cselect_b32 s50, s52, s50
    s_bitcmp1_b32 s49, 1
    s_cselect_b32 s24, s10, s8
    s_cselect_b32 s25, s11, s9
    s_and_b32 s49, s49, 1
    s_lshl_b32 s51, s49, 4
    s_add_u32 s51, s51, s50
    s_mul_i32 s51, s51, 18
    s_lshl_b32 s48, s47, 3
    s_add_u32 s51, s51, s48
    s_lshl_b32 s49, s49, 1
    s_add_u32 s49, s49, s50
    s_sub_u32 s49, s49, 16
    s_lshl_b32 s49, s49, 1
    s_add_u32 s49, s49, s47
    s_mul_i32 s49, s49, 72
    s_add_u32 s49, s49, 16
    s_movk_i32 s48, 2304
    s_cmp_ge_u32 s50, 16
    s_cselect_b32 s51, s49, s51
    s_cselect_b32 s48, 20736, s48
    s_mul_i32 s51, s51, 1152
    s_lshl_b32 s49, s46, 7
    s_add_u32 s51, s51, s49
    s_cmp_ge_u32 s44, 1296
    s_cselect_b32 s51, 0, s51

    buffer_load_ushort v20, v3, s[24:27], s51 offen
    buffer_load_ushort v52, v3, s[24:27], s51 offen offset:1152
    s_add_u32 s51, s51, s48
    buffer_load_ushort v21, v3, s[24:27], s51 offen
    buffer_load_ushort v53, v3, s[24:27], s51 offen offset:1152
    s_add_u32 s51, s51, s48
    buffer_load_ushort v22, v3, s[24:27], s51 offen
    buffer_load_ushort v54, v3, s[24:27], s51 offen offset:1152
    s_add_u32 s51, s51, s48
    buffer_load_ushort v23, v3, s[24:27], s51 offen
    buffer_load_ushort v55, v3, s[24:27], s51 offen offset:1152
    s_add_u32 s44, s2, 512
    s_mul_hi_u32 s45, s44, 477218589
    s_mul_i32 s46, s45, 9
    s_sub_u32 s46, s44, s46
    s_and_b32 s47, s45, 1
    s_lshr_b32 s48, s45, 1
    s_lshr_b32 s49, s48, 4
    s_and_b32 s50, s48, 15
    s_and_b32 s51, s48, 3
    s_lshr_b32 s52, s48, 2
    s_cmp_ge_u32 s48, 64
    s_cselect_b32 s49, s51, s49
    s_cselect_b32 s50, s52, s50
    s_bitcmp1_b32 s49, 1
    s_cselect_b32 s24, s10, s8
    s_cselect_b32 s25, s11, s9
    s_and_b32 s49, s49, 1
    s_lshl_b32 s51, s49, 4
    s_add_u32 s51, s51, s50
    s_mul_i32 s51, s51, 18
    s_lshl_b32 s48, s47, 3
    s_add_u32 s51, s51, s48
    s_lshl_b32 s49, s49, 1
    s_add_u32 s49, s49, s50
    s_sub_u32 s49, s49, 16
    s_lshl_b32 s49, s49, 1
    s_add_u32 s49, s49, s47
    s_mul_i32 s49, s49, 72
    s_add_u32 s49, s49, 16
    s_movk_i32 s48, 2304
    s_cmp_ge_u32 s50, 16
    s_cselect_b32 s51, s49, s51
    s_cselect_b32 s48, 20736, s48
    s_mul_i32 s51, s51, 1152
    s_lshl_b32 s49, s46, 7
    s_add_u32 s51, s51, s49
    s_cmp_ge_u32 s44, 1296
    s_cselect_b32 s51, 0, s51

    buffer_load_ushort v24, v3, s[24:27], s51 offen
    buffer_load_ushort v56, v3, s[24:27], s51 offen offset:1152
    s_add_u32 s51, s51, s48
    buffer_load_ushort v25, v3, s[24:27], s51 offen
    buffer_load_ushort v57, v3, s[24:27], s51 offen offset:1152
    s_add_u32 s51, s51, s48
    buffer_load_ushort v26, v3, s[24:27], s51 offen
    buffer_load_ushort v58, v3, s[24:27], s51 offen offset:1152
    s_add_u32 s51, s51, s48
    buffer_load_ushort v27, v3, s[24:27], s51 offen
    buffer_load_ushort v59, v3, s[24:27], s51 offen offset:1152
    s_add_u32 s44, s2, 768
    s_mul_hi_u32 s45, s44, 477218589
    s_mul_i32 s46, s45, 9
    s_sub_u32 s46, s44, s46
    s_and_b32 s47, s45, 1
    s_lshr_b32 s48, s45, 1
    s_lshr_b32 s49, s48, 4
    s_and_b32 s50, s48, 15
    s_and_b32 s51, s48, 3
    s_lshr_b32 s52, s48, 2
    s_cmp_ge_u32 s48, 64
    s_cselect_b32 s49, s51, s49
    s_cselect_b32 s50, s52, s50
    s_bitcmp1_b32 s49, 1
    s_cselect_b32 s24, s10, s8
    s_cselect_b32 s25, s11, s9
    s_and_b32 s49, s49, 1
    s_lshl_b32 s51, s49, 4
    s_add_u32 s51, s51, s50
    s_mul_i32 s51, s51, 18
    s_lshl_b32 s48, s47, 3
    s_add_u32 s51, s51, s48
    s_lshl_b32 s49, s49, 1
    s_add_u32 s49, s49, s50
    s_sub_u32 s49, s49, 16
    s_lshl_b32 s49, s49, 1
    s_add_u32 s49, s49, s47
    s_mul_i32 s49, s49, 72
    s_add_u32 s49, s49, 16
    s_movk_i32 s48, 2304
    s_cmp_ge_u32 s50, 16
    s_cselect_b32 s51, s49, s51
    s_cselect_b32 s48, 20736, s48
    s_mul_i32 s51, s51, 1152
    s_lshl_b32 s49, s46, 7
    s_add_u32 s51, s51, s49
    s_cmp_ge_u32 s44, 1296
    s_cselect_b32 s51, 0, s51

    buffer_load_ushort v28, v3, s[24:27], s51 offen
    buffer_load_ushort v60, v3, s[24:27], s51 offen offset:1152
    s_add_u32 s51, s51, s48
    buffer_load_ushort v29, v3, s[24:27], s51 offen
    buffer_load_ushort v61, v3, s[24:27], s51 offen offset:1152
    s_add_u32 s51, s51, s48
    buffer_load_ushort v30, v3, s[24:27], s51 offen
    buffer_load_ushort v62, v3, s[24:27], s51 offen offset:1152
    s_add_u32 s51, s51, s48
    buffer_load_ushort v31, v3, s[24:27], s51 offen
    buffer_load_ushort v63, v3, s[24:27], s51 offen offset:1152
    s_add_u32 s44, s2, 1024
    s_mul_hi_u32 s45, s44, 477218589
    s_mul_i32 s46, s45, 9
    s_sub_u32 s46, s44, s46
    s_and_b32 s47, s45, 1
    s_lshr_b32 s48, s45, 1
    s_lshr_b32 s49, s48, 4
    s_and_b32 s50, s48, 15
    s_and_b32 s51, s48, 3
    s_lshr_b32 s52, s48, 2
    s_cmp_ge_u32 s48, 64
    s_cselect_b32 s49, s51, s49
    s_cselect_b32 s50, s52, s50
    s_bitcmp1_b32 s49, 1
    s_cselect_b32 s24, s10, s8
    s_cselect_b32 s25, s11, s9
    s_and_b32 s49, s49, 1
    s_lshl_b32 s51, s49, 4
    s_add_u32 s51, s51, s50
    s_mul_i32 s51, s51, 18
    s_lshl_b32 s48, s47, 3
    s_add_u32 s51, s51, s48
    s_lshl_b32 s49, s49, 1
    s_add_u32 s49, s49, s50
    s_sub_u32 s49, s49, 16
    s_lshl_b32 s49, s49, 1
    s_add_u32 s49, s49, s47
    s_mul_i32 s49, s49, 72
    s_add_u32 s49, s49, 16
    s_movk_i32 s48, 2304
    s_cmp_ge_u32 s50, 16
    s_cselect_b32 s51, s49, s51
    s_cselect_b32 s48, 20736, s48
    s_mul_i32 s51, s51, 1152
    s_lshl_b32 s49, s46, 7
    s_add_u32 s51, s51, s49
    s_cmp_ge_u32 s44, 1296
    s_cselect_b32 s51, 0, s51

    buffer_load_ushort v32, v3, s[24:27], s51 offen
    buffer_load_ushort v64, v3, s[24:27], s51 offen offset:1152
    s_add_u32 s51, s51, s48
    buffer_load_ushort v33, v3, s[24:27], s51 offen
    buffer_load_ushort v65, v3, s[24:27], s51 offen offset:1152
    s_add_u32 s51, s51, s48
    buffer_load_ushort v34, v3, s[24:27], s51 offen
    buffer_load_ushort v66, v3, s[24:27], s51 offen offset:1152
    s_add_u32 s51, s51, s48
    buffer_load_ushort v35, v3, s[24:27], s51 offen
    buffer_load_ushort v67, v3, s[24:27], s51 offen offset:1152
    s_add_u32 s44, s2, 1280
    s_mul_hi_u32 s45, s44, 477218589
    s_mul_i32 s46, s45, 9
    s_sub_u32 s46, s44, s46
    s_and_b32 s47, s45, 1
    s_lshr_b32 s48, s45, 1
    s_lshr_b32 s49, s48, 4
    s_and_b32 s50, s48, 15
    s_and_b32 s51, s48, 3
    s_lshr_b32 s52, s48, 2
    s_cmp_ge_u32 s48, 64
    s_cselect_b32 s49, s51, s49
    s_cselect_b32 s50, s52, s50
    s_bitcmp1_b32 s49, 1
    s_cselect_b32 s24, s10, s8
    s_cselect_b32 s25, s11, s9
    s_and_b32 s49, s49, 1
    s_lshl_b32 s51, s49, 4
    s_add_u32 s51, s51, s50
    s_mul_i32 s51, s51, 18
    s_lshl_b32 s48, s47, 3
    s_add_u32 s51, s51, s48
    s_lshl_b32 s49, s49, 1
    s_add_u32 s49, s49, s50
    s_sub_u32 s49, s49, 16
    s_lshl_b32 s49, s49, 1
    s_add_u32 s49, s49, s47
    s_mul_i32 s49, s49, 72
    s_add_u32 s49, s49, 16
    s_movk_i32 s48, 2304
    s_cmp_ge_u32 s50, 16
    s_cselect_b32 s51, s49, s51
    s_cselect_b32 s48, 20736, s48
    s_mul_i32 s51, s51, 1152
    s_lshl_b32 s49, s46, 7
    s_add_u32 s51, s51, s49
    s_cmp_ge_u32 s44, 1296
    s_cselect_b32 s51, 0, s51

    buffer_load_ushort v36, v3, s[24:27], s51 offen
    buffer_load_ushort v68, v3, s[24:27], s51 offen offset:1152
    s_add_u32 s51, s51, s48
    buffer_load_ushort v37, v3, s[24:27], s51 offen
    buffer_load_ushort v69, v3, s[24:27], s51 offen offset:1152
    s_add_u32 s51, s51, s48
    buffer_load_ushort v38, v3, s[24:27], s51 offen
    buffer_load_ushort v70, v3, s[24:27], s51 offen offset:1152
    s_add_u32 s51, s51, s48
    buffer_load_ushort v39, v3, s[24:27], s51 offen
    buffer_load_ushort v71, v3, s[24:27], s51 offen offset:1152
    s_add_u32 s44, s2, 0
    s_mul_hi_u32 s45, s44, 477218589
    s_mul_i32 s46, s45, 9
    s_sub_u32 s46, s44, s46
    s_mul_i32 s45, s45, 1152
    s_add_u32 s45, s45, 14467072
    s_cmp_ge_u32 s44, 1296
    s_cselect_b32 s45, 0x7ff00000, s45
    s_lshl_b32 s46, s46, 6
    v_add_u32 v4, s46, v1
    v_mul_u32_u24 v5, 911, v4
    v_lshrrev_b32 v5, 16, v5
    v_mul_lo_u32 v5, v5, s53
    v_lshl_add_u32 v4, v4, 4, v5
    v_add_u32 v8, s45, v4

    s_add_u32 s44, s2, 256
    s_mul_hi_u32 s45, s44, 477218589
    s_mul_i32 s46, s45, 9
    s_sub_u32 s46, s44, s46
    s_mul_i32 s45, s45, 1152
    s_add_u32 s45, s45, 14467072
    s_cmp_ge_u32 s44, 1296
    s_cselect_b32 s45, 0x7ff00000, s45
    s_lshl_b32 s46, s46, 6
    v_add_u32 v4, s46, v1
    v_mul_u32_u24 v5, 911, v4
    v_lshrrev_b32 v5, 16, v5
    v_mul_lo_u32 v5, v5, s53
    v_lshl_add_u32 v4, v4, 4, v5
    v_add_u32 v9, s45, v4

    s_add_u32 s44, s2, 512
    s_mul_hi_u32 s45, s44, 477218589
    s_mul_i32 s46, s45, 9
    s_sub_u32 s46, s44, s46
    s_mul_i32 s45, s45, 1152
    s_add_u32 s45, s45, 14467072
    s_cmp_ge_u32 s44, 1296
    s_cselect_b32 s45, 0x7ff00000, s45
    s_lshl_b32 s46, s46, 6
    v_add_u32 v4, s46, v1
    v_mul_u32_u24 v5, 911, v4
    v_lshrrev_b32 v5, 16, v5
    v_mul_lo_u32 v5, v5, s53
    v_lshl_add_u32 v4, v4, 4, v5
    v_add_u32 v10, s45, v4

    s_add_u32 s44, s2, 768
    s_mul_hi_u32 s45, s44, 477218589
    s_mul_i32 s46, s45, 9
    s_sub_u32 s46, s44, s46
    s_mul_i32 s45, s45, 1152
    s_add_u32 s45, s45, 14467072
    s_cmp_ge_u32 s44, 1296
    s_cselect_b32 s45, 0x7ff00000, s45
    s_lshl_b32 s46, s46, 6
    v_add_u32 v4, s46, v1
    v_mul_u32_u24 v5, 911, v4
    v_lshrrev_b32 v5, 16, v5
    v_mul_lo_u32 v5, v5, s53
    v_lshl_add_u32 v4, v4, 4, v5
    v_add_u32 v11, s45, v4

    s_add_u32 s44, s2, 1024
    s_mul_hi_u32 s45, s44, 477218589
    s_mul_i32 s46, s45, 9
    s_sub_u32 s46, s44, s46
    s_mul_i32 s45, s45, 1152
    s_add_u32 s45, s45, 14467072
    s_cmp_ge_u32 s44, 1296
    s_cselect_b32 s45, 0x7ff00000, s45
    s_lshl_b32 s46, s46, 6
    v_add_u32 v4, s46, v1
    v_mul_u32_u24 v5, 911, v4
    v_lshrrev_b32 v5, 16, v5
    v_mul_lo_u32 v5, v5, s53
    v_lshl_add_u32 v4, v4, 4, v5
    v_add_u32 v12, s45, v4

    s_add_u32 s44, s2, 1280
    s_mul_hi_u32 s45, s44, 477218589
    s_mul_i32 s46, s45, 9
    s_sub_u32 s46, s44, s46
    s_mul_i32 s45, s45, 1152
    s_add_u32 s45, s45, 14467072
    s_cmp_ge_u32 s44, 1296
    s_cselect_b32 s45, 0x7ff00000, s45
    s_lshl_b32 s46, s46, 6
    v_add_u32 v4, s46, v1
    v_mul_u32_u24 v5, 911, v4
    v_lshrrev_b32 v5, 16, v5
    v_mul_lo_u32 v5, v5, s53
    v_lshl_add_u32 v4, v4, 4, v5
    v_add_u32 v13, s45, v4

    s_waitcnt vmcnt(0)
    v_lshl_or_b32 v16, v48, 16, v16
    v_lshl_or_b32 v17, v49, 16, v17
    v_lshl_or_b32 v18, v50, 16, v18
    v_lshl_or_b32 v19, v51, 16, v19
    buffer_store_dwordx4 v[16:19], v8, s[20:23], 0 offen sc0 sc1
    v_lshl_or_b32 v20, v52, 16, v20
    v_lshl_or_b32 v21, v53, 16, v21
    v_lshl_or_b32 v22, v54, 16, v22
    v_lshl_or_b32 v23, v55, 16, v23
    buffer_store_dwordx4 v[20:23], v9, s[20:23], 0 offen sc0 sc1
    v_lshl_or_b32 v24, v56, 16, v24
    v_lshl_or_b32 v25, v57, 16, v25
    v_lshl_or_b32 v26, v58, 16, v26
    v_lshl_or_b32 v27, v59, 16, v27
    buffer_store_dwordx4 v[24:27], v10, s[20:23], 0 offen sc0 sc1
    v_lshl_or_b32 v28, v60, 16, v28
    v_lshl_or_b32 v29, v61, 16, v29
    v_lshl_or_b32 v30, v62, 16, v30
    v_lshl_or_b32 v31, v63, 16, v31
    buffer_store_dwordx4 v[28:31], v11, s[20:23], 0 offen sc0 sc1
    v_lshl_or_b32 v32, v64, 16, v32
    v_lshl_or_b32 v33, v65, 16, v33
    v_lshl_or_b32 v34, v66, 16, v34
    v_lshl_or_b32 v35, v67, 16, v35
    buffer_store_dwordx4 v[32:35], v12, s[20:23], 0 offen sc0 sc1
    v_lshl_or_b32 v36, v68, 16, v36
    v_lshl_or_b32 v37, v69, 16, v37
    v_lshl_or_b32 v38, v70, 16, v38
    v_lshl_or_b32 v39, v71, 16, v39
    buffer_store_dwordx4 v[36:39], v13, s[20:23], 0 offen sc0 sc1
    s_lshl_b32 s44, s2, 6
    s_add_u32 s44, s44, 15941632
    s_waitcnt vmcnt(0)
    buffer_store_dword v15, v14, s[20:23], s44 offen sc0 sc1

    s_mov_b32 s40, 0
L2_poll:
    s_sleep 8
    s_mov_b32 s44, 15941632
    buffer_load_dword v16, v7, s[20:23], s44 offen sc1
    s_mov_b32 s44, 15945728
    buffer_load_dword v17, v7, s[20:23], s44 offen sc1
    s_mov_b32 s44, 15949824
    buffer_load_dword v18, v7, s[20:23], s44 offen sc1
    s_mov_b32 s44, 15953920
    buffer_load_dword v19, v7, s[20:23], s44 offen sc1
    s_waitcnt vmcnt(0)
    v_and_b32 v16, v16, v17
    v_and_b32 v18, v18, v19
    v_and_b32 v16, v16, v18
    v_cmp_eq_u32 vcc, 1, v16
    s_add_u32 s40, s40, 1
    s_nop 3
    s_cmp_eq_u64 vcc, -1
    s_cbranch_scc1 L2_polled
    s_cmp_lt_u32 s40, 20000
    s_cbranch_scc1 L2_poll

L2_polled:
    ds_write_b32 v6, v15 offset:20
    s_mov_b32 s12, 0
    s_and_b32 s12, s12, 3
    s_mul_i32 s12, s12, 9216
    s_add_u32 s12, s12, s37
    s_mov_b32 s13, 1
    s_and_b32 s13, s13, 3
    s_mul_i32 s13, s13, 9216
    s_add_u32 s13, s13, s37
    s_mov_b32 s14, 2
    s_and_b32 s14, s14, 3
    s_mul_i32 s14, s14, 9216
    s_add_u32 s14, s14, s37
    s_mov_b32 s15, 3
    s_and_b32 s15, s15, 3
    s_mul_i32 s15, s15, 9216
    s_add_u32 s15, s15, s37
    s_mov_b32 m0, 151552
    s_add_u32 s45, s37, 147456
    buffer_load_dwordx4 v2, s[20:23], s45 offen sc1 lds
    s_mov_b32 m0, 152576
    s_add_u32 s45, s37, 148480
    buffer_load_dwordx4 v2, s[20:23], s45 offen sc1 lds
    s_mov_b32 m0, 153600
    s_add_u32 s45, s37, 149504
    buffer_load_dwordx4 v2, s[20:23], s45 offen sc1 lds
    s_mov_b32 m0, 154624
    s_add_u32 s45, s37, 150528
    buffer_load_dwordx4 v2, s[20:23], s45 offen sc1 lds
    s_mov_b32 m0, 155648
    s_add_u32 s45, s37, 151552
    buffer_load_dwordx4 v2, s[20:23], s45 offen sc1 lds
    s_mov_b32 m0, 156672
    s_add_u32 s45, s37, 152576
    buffer_load_dwordx4 v2, s[20:23], s45 offen sc1 lds
    s_mov_b32 m0, 157696
    s_add_u32 s45, s37, 153600
    buffer_load_dwordx4 v2, s[20:23], s45 offen sc1 lds
    s_mov_b32 m0, 158720
    s_add_u32 s45, s37, 154624
    buffer_load_dwordx4 v2, s[20:23], s45 offen sc1 lds
    s_mov_b32 m0, 159744
    s_add_u32 s45, s37, 155648
    buffer_load_dwordx4 v2, s[20:23], s45 offen sc1 lds
L2_lw0:
    s_sleep 16
    ds_read_b32 v8, v6 offset:0
    s_waitcnt lgkmcnt(0)
    v_readfirstlane_b32 s44, v8
    s_nop 3
    s_cmp_lt_u32 s44, 512
    s_cbranch_scc1 L2_lw0

    s_mov_b32 m0, 0
    s_add_u32 s45, s12, 0
    buffer_load_dwordx4 v2, s[20:23], s45 offen sc1 lds
    s_mov_b32 m0, 1024
    s_add_u32 s45, s12, 1024
    buffer_load_dwordx4 v2, s[20:23], s45 offen sc1 lds
    s_mov_b32 m0, 2048
    s_add_u32 s45, s12, 2048
    buffer_load_dwordx4 v2, s[20:23], s45 offen sc1 lds
    s_mov_b32 m0, 3072
    s_add_u32 s45, s12, 3072
    buffer_load_dwordx4 v2, s[20:23], s45 offen sc1 lds
    s_mov_b32 m0, 4096
    s_add_u32 s45, s12, 4096
    buffer_load_dwordx4 v2, s[20:23], s45 offen sc1 lds
    s_mov_b32 m0, 5120
    s_add_u32 s45, s12, 5120
    buffer_load_dwordx4 v2, s[20:23], s45 offen sc1 lds
    s_mov_b32 m0, 6144
    s_add_u32 s45, s12, 6144
    buffer_load_dwordx4 v2, s[20:23], s45 offen sc1 lds
    s_mov_b32 m0, 7168
    s_add_u32 s45, s12, 7168
    buffer_load_dwordx4 v2, s[20:23], s45 offen sc1 lds
    s_mov_b32 m0, 8192
    s_add_u32 s45, s12, 8192
    buffer_load_dwordx4 v2, s[20:23], s45 offen sc1 lds
    s_mov_b32 m0, 9216
    s_add_u32 s45, s13, 0
    buffer_load_dwordx4 v2, s[20:23], s45 offen sc1 lds
    s_mov_b32 m0, 10240
    s_add_u32 s45, s13, 1024
    buffer_load_dwordx4 v2, s[20:23], s45 offen sc1 lds
    s_mov_b32 m0, 11264
    s_add_u32 s45, s13, 2048
    buffer_load_dwordx4 v2, s[20:23], s45 offen sc1 lds
    s_mov_b32 m0, 12288
    s_add_u32 s45, s13, 3072
    buffer_load_dwordx4 v2, s[20:23], s45 offen sc1 lds
    s_mov_b32 m0, 13312
    s_add_u32 s45, s13, 4096
    buffer_load_dwordx4 v2, s[20:23], s45 offen sc1 lds
    s_mov_b32 m0, 14336
    s_add_u32 s45, s13, 5120
    buffer_load_dwordx4 v2, s[20:23], s45 offen sc1 lds
    s_mov_b32 m0, 15360
    s_add_u32 s45, s13, 6144
    buffer_load_dwordx4 v2, s[20:23], s45 offen sc1 lds
    s_mov_b32 m0, 16384
    s_add_u32 s45, s13, 7168
    buffer_load_dwordx4 v2, s[20:23], s45 offen sc1 lds
    s_mov_b32 m0, 17408
    s_add_u32 s45, s13, 8192
    buffer_load_dwordx4 v2, s[20:23], s45 offen sc1 lds
    s_mov_b32 m0, 18432
    s_add_u32 s45, s14, 0
    buffer_load_dwordx4 v2, s[20:23], s45 offen sc1 lds
    s_mov_b32 m0, 19456
    s_add_u32 s45, s14, 1024
    buffer_load_dwordx4 v2, s[20:23], s45 offen sc1 lds
    s_mov_b32 m0, 20480
    s_add_u32 s45, s14, 2048
    buffer_load_dwordx4 v2, s[20:23], s45 offen sc1 lds
    s_mov_b32 m0, 21504
    s_add_u32 s45, s14, 3072
    buffer_load_dwordx4 v2, s[20:23], s45 offen sc1 lds
    s_mov_b32 m0, 22528
    s_add_u32 s45, s14, 4096
    buffer_load_dwordx4 v2, s[20:23], s45 offen sc1 lds
    s_mov_b32 m0, 23552
    s_add_u32 s45, s14, 5120
    buffer_load_dwordx4 v2, s[20:23], s45 offen sc1 lds
    s_mov_b32 m0, 24576
    s_add_u32 s45, s14, 6144
    buffer_load_dwordx4 v2, s[20:23], s45 offen sc1 lds
    s_mov_b32 m0, 25600
    s_add_u32 s45, s14, 7168
    buffer_load_dwordx4 v2, s[20:23], s45 offen sc1 lds
    s_mov_b32 m0, 26624
    s_add_u32 s45, s14, 8192
    buffer_load_dwordx4 v2, s[20:23], s45 offen sc1 lds
    s_mov_b32 m0, 27648
    s_add_u32 s45, s15, 0
    buffer_load_dwordx4 v2, s[20:23], s45 offen sc1 lds
    s_mov_b32 m0, 28672
    s_add_u32 s45, s15, 1024
    buffer_load_dwordx4 v2, s[20:23], s45 offen sc1 lds
    s_mov_b32 m0, 29696
    s_add_u32 s45, s15, 2048
    buffer_load_dwordx4 v2, s[20:23], s45 offen sc1 lds
    s_mov_b32 m0, 30720
    s_add_u32 s45, s15, 3072
    buffer_load_dwordx4 v2, s[20:23], s45 offen sc1 lds
    s_mov_b32 m0, 31744
    s_add_u32 s45, s15, 4096
    buffer_load_dwordx4 v2, s[20:23], s45 offen sc1 lds
    s_mov_b32 m0, 32768
    s_add_u32 s45, s15, 5120
    buffer_load_dwordx4 v2, s[20:23], s45 offen sc1 lds
    s_mov_b32 m0, 33792
    s_add_u32 s45, s15, 6144
    buffer_load_dwordx4 v2, s[20:23], s45 offen sc1 lds
    s_mov_b32 m0, 34816
    s_add_u32 s45, s15, 7168
    buffer_load_dwordx4 v2, s[20:23], s45 offen sc1 lds
    s_mov_b32 m0, 35840
    s_add_u32 s45, s15, 8192
    buffer_load_dwordx4 v2, s[20:23], s45 offen sc1 lds
    s_mov_b32 m0, 36864
    s_add_u32 s45, s12, 36864
    buffer_load_dwordx4 v2, s[20:23], s45 offen sc1 lds
    s_mov_b32 m0, 37888
    s_add_u32 s45, s12, 37888
    buffer_load_dwordx4 v2, s[20:23], s45 offen sc1 lds
    s_mov_b32 m0, 38912
    s_add_u32 s45, s12, 38912
    buffer_load_dwordx4 v2, s[20:23], s45 offen sc1 lds
    s_mov_b32 m0, 39936
    s_add_u32 s45, s12, 39936
    buffer_load_dwordx4 v2, s[20:23], s45 offen sc1 lds
    s_mov_b32 m0, 40960
    s_add_u32 s45, s12, 40960
    buffer_load_dwordx4 v2, s[20:23], s45 offen sc1 lds
    s_mov_b32 m0, 41984
    s_add_u32 s45, s12, 41984
    buffer_load_dwordx4 v2, s[20:23], s45 offen sc1 lds
    s_mov_b32 m0, 43008
    s_add_u32 s45, s12, 43008
    buffer_load_dwordx4 v2, s[20:23], s45 offen sc1 lds
    s_mov_b32 m0, 44032
    s_add_u32 s45, s12, 44032
    buffer_load_dwordx4 v2, s[20:23], s45 offen sc1 lds
    s_mov_b32 m0, 45056
    s_add_u32 s45, s12, 45056
    buffer_load_dwordx4 v2, s[20:23], s45 offen sc1 lds
    s_mov_b32 m0, 46080
    s_add_u32 s45, s13, 36864
    buffer_load_dwordx4 v2, s[20:23], s45 offen sc1 lds
    s_mov_b32 m0, 47104
    s_add_u32 s45, s13, 37888
    buffer_load_dwordx4 v2, s[20:23], s45 offen sc1 lds
    s_mov_b32 m0, 48128
    s_add_u32 s45, s13, 38912
    buffer_load_dwordx4 v2, s[20:23], s45 offen sc1 lds
    s_mov_b32 m0, 49152
    s_add_u32 s45, s13, 39936
    buffer_load_dwordx4 v2, s[20:23], s45 offen sc1 lds
    s_mov_b32 m0, 50176
    s_add_u32 s45, s13, 40960
    buffer_load_dwordx4 v2, s[20:23], s45 offen sc1 lds
    s_mov_b32 m0, 51200
    s_add_u32 s45, s13, 41984
    buffer_load_dwordx4 v2, s[20:23], s45 offen sc1 lds
    s_mov_b32 m0, 52224
    s_add_u32 s45, s13, 43008
    buffer_load_dwordx4 v2, s[20:23], s45 offen sc1 lds
    s_mov_b32 m0, 53248
    s_add_u32 s45, s13, 44032
    buffer_load_dwordx4 v2, s[20:23], s45 offen sc1 lds
    s_mov_b32 m0, 54272
    s_add_u32 s45, s13, 45056
    buffer_load_dwordx4 v2, s[20:23], s45 offen sc1 lds
    s_mov_b32 m0, 55296
    s_add_u32 s45, s14, 36864
    buffer_load_dwordx4 v2, s[20:23], s45 offen sc1 lds
    s_mov_b32 m0, 56320
    s_add_u32 s45, s14, 37888
    buffer_load_dwordx4 v2, s[20:23], s45 offen sc1 lds
    s_mov_b32 m0, 57344
    s_add_u32 s45, s14, 38912
    buffer_load_dwordx4 v2, s[20:23], s45 offen sc1 lds
    s_mov_b32 m0, 58368
    s_add_u32 s45, s14, 39936
    buffer_load_dwordx4 v2, s[20:23], s45 offen sc1 lds
    s_mov_b32 m0, 59392
    s_add_u32 s45, s14, 40960
    buffer_load_dwordx4 v2, s[20:23], s45 offen sc1 lds
    s_mov_b32 m0, 60416
    s_add_u32 s45, s14, 41984
    buffer_load_dwordx4 v2, s[20:23], s45 offen sc1 lds
    s_mov_b32 m0, 61440
    s_add_u32 s45, s14, 43008
    buffer_load_dwordx4 v2, s[20:23], s45 offen sc1 lds
    s_mov_b32 m0, 62464
    s_add_u32 s45, s14, 44032
    buffer_load_dwordx4 v2, s[20:23], s45 offen sc1 lds
    s_mov_b32 m0, 63488
    s_add_u32 s45, s14, 45056
    buffer_load_dwordx4 v2, s[20:23], s45 offen sc1 lds
    s_mov_b32 m0, 64512
    s_add_u32 s45, s15, 36864
    buffer_load_dwordx4 v2, s[20:23], s45 offen sc1 lds
    s_mov_b32 m0, 65536
    s_add_u32 s45, s15, 37888
    buffer_load_dwordx4 v2, s[20:23], s45 offen sc1 lds
    s_mov_b32 m0, 66560
    s_add_u32 s45, s15, 38912
    buffer_load_dwordx4 v2, s[20:23], s45 offen sc1 lds
    s_mov_b32 m0, 67584
    s_add_u32 s45, s15, 39936
    buffer_load_dwordx4 v2, s[20:23], s45 offen sc1 lds
    s_mov_b32 m0, 68608
    s_add_u32 s45, s15, 40960
    buffer_load_dwordx4 v2, s[20:23], s45 offen sc1 lds
    s_mov_b32 m0, 69632
    s_add_u32 s45, s15, 41984
    buffer_load_dwordx4 v2, s[20:23], s45 offen sc1 lds
    s_mov_b32 m0, 70656
    s_add_u32 s45, s15, 43008
    buffer_load_dwordx4 v2, s[20:23], s45 offen sc1 lds
    s_mov_b32 m0, 71680
    s_add_u32 s45, s15, 44032
    buffer_load_dwordx4 v2, s[20:23], s45 offen sc1 lds
    s_mov_b32 m0, 72704
    s_add_u32 s45, s15, 45056
    buffer_load_dwordx4 v2, s[20:23], s45 offen sc1 lds
    s_mov_b32 m0, 73728
    s_add_u32 s45, s12, 73728
    buffer_load_dwordx4 v2, s[20:23], s45 offen sc1 lds
    s_mov_b32 m0, 74752
    s_add_u32 s45, s12, 74752
    buffer_load_dwordx4 v2, s[20:23], s45 offen sc1 lds
    s_mov_b32 m0, 75776
    s_add_u32 s45, s12, 75776
    buffer_load_dwordx4 v2, s[20:23], s45 offen sc1 lds
    s_mov_b32 m0, 76800
    s_add_u32 s45, s12, 76800
    buffer_load_dwordx4 v2, s[20:23], s45 offen sc1 lds
    s_mov_b32 m0, 77824
    s_add_u32 s45, s12, 77824
    buffer_load_dwordx4 v2, s[20:23], s45 offen sc1 lds
    s_mov_b32 m0, 78848
    s_add_u32 s45, s12, 78848
    buffer_load_dwordx4 v2, s[20:23], s45 offen sc1 lds
    s_mov_b32 m0, 79872
    s_add_u32 s45, s12, 79872
    buffer_load_dwordx4 v2, s[20:23], s45 offen sc1 lds
    s_mov_b32 m0, 80896
    s_add_u32 s45, s12, 80896
    buffer_load_dwordx4 v2, s[20:23], s45 offen sc1 lds
    s_mov_b32 m0, 81920
    s_add_u32 s45, s12, 81920
    buffer_load_dwordx4 v2, s[20:23], s45 offen sc1 lds
    s_mov_b32 m0, 82944
    s_add_u32 s45, s13, 73728
    buffer_load_dwordx4 v2, s[20:23], s45 offen sc1 lds
    s_mov_b32 m0, 83968
    s_add_u32 s45, s13, 74752
    buffer_load_dwordx4 v2, s[20:23], s45 offen sc1 lds
    s_mov_b32 m0, 84992
    s_add_u32 s45, s13, 75776
    buffer_load_dwordx4 v2, s[20:23], s45 offen sc1 lds
    s_mov_b32 m0, 86016
    s_add_u32 s45, s13, 76800
    buffer_load_dwordx4 v2, s[20:23], s45 offen sc1 lds
    s_mov_b32 m0, 87040
    s_add_u32 s45, s13, 77824
    buffer_load_dwordx4 v2, s[20:23], s45 offen sc1 lds
    s_mov_b32 m0, 88064
    s_add_u32 s45, s13, 78848
    buffer_load_dwordx4 v2, s[20:23], s45 offen sc1 lds
    s_mov_b32 m0, 89088
    s_add_u32 s45, s13, 79872
    buffer_load_dwordx4 v2, s[20:23], s45 offen sc1 lds
    s_mov_b32 m0, 90112
    s_add_u32 s45, s13, 80896
    buffer_load_dwordx4 v2, s[20:23], s45 offen sc1 lds
    s_mov_b32 m0, 91136
    s_add_u32 s45, s13, 81920
    buffer_load_dwordx4 v2, s[20:23], s45 offen sc1 lds
    s_mov_b32 m0, 92160
    s_add_u32 s45, s14, 73728
    buffer_load_dwordx4 v2, s[20:23], s45 offen sc1 lds
    s_mov_b32 m0, 93184
    s_add_u32 s45, s14, 74752
    buffer_load_dwordx4 v2, s[20:23], s45 offen sc1 lds
    s_mov_b32 m0, 94208
    s_add_u32 s45, s14, 75776
    buffer_load_dwordx4 v2, s[20:23], s45 offen sc1 lds
    s_mov_b32 m0, 95232
    s_add_u32 s45, s14, 76800
    buffer_load_dwordx4 v2, s[20:23], s45 offen sc1 lds
    s_mov_b32 m0, 96256
    s_add_u32 s45, s14, 77824
    buffer_load_dwordx4 v2, s[20:23], s45 offen sc1 lds
    s_mov_b32 m0, 97280
    s_add_u32 s45, s14, 78848
    buffer_load_dwordx4 v2, s[20:23], s45 offen sc1 lds
    s_mov_b32 m0, 98304
    s_add_u32 s45, s14, 79872
    buffer_load_dwordx4 v2, s[20:23], s45 offen sc1 lds
    s_mov_b32 m0, 99328
    s_add_u32 s45, s14, 80896
    buffer_load_dwordx4 v2, s[20:23], s45 offen sc1 lds
    s_mov_b32 m0, 100352
    s_add_u32 s45, s14, 81920
    buffer_load_dwordx4 v2, s[20:23], s45 offen sc1 lds
    s_mov_b32 m0, 101376
    s_add_u32 s45, s15, 73728
    buffer_load_dwordx4 v2, s[20:23], s45 offen sc1 lds
    s_mov_b32 m0, 102400
    s_add_u32 s45, s15, 74752
    buffer_load_dwordx4 v2, s[20:23], s45 offen sc1 lds
    s_mov_b32 m0, 103424
    s_add_u32 s45, s15, 75776
    buffer_load_dwordx4 v2, s[20:23], s45 offen sc1 lds
    s_mov_b32 m0, 104448
    s_add_u32 s45, s15, 76800
    buffer_load_dwordx4 v2, s[20:23], s45 offen sc1 lds
    s_mov_b32 m0, 105472
    s_add_u32 s45, s15, 77824
    buffer_load_dwordx4 v2, s[20:23], s45 offen sc1 lds
    s_mov_b32 m0, 106496
    s_add_u32 s45, s15, 78848
    buffer_load_dwordx4 v2, s[20:23], s45 offen sc1 lds
    s_mov_b32 m0, 107520
    s_add_u32 s45, s15, 79872
    buffer_load_dwordx4 v2, s[20:23], s45 offen sc1 lds
    s_mov_b32 m0, 108544
    s_add_u32 s45, s15, 80896
    buffer_load_dwordx4 v2, s[20:23], s45 offen sc1 lds
    s_mov_b32 m0, 109568
    s_add_u32 s45, s15, 81920
    buffer_load_dwordx4 v2, s[20:23], s45 offen sc1 lds
    s_mov_b32 m0, 110592
    s_add_u32 s45, s12, 110592
    buffer_load_dwordx4 v2, s[20:23], s45 offen sc1 lds
    s_mov_b32 m0, 111616
    s_add_u32 s45, s12, 111616
    buffer_load_dwordx4 v2, s[20:23], s45 offen sc1 lds
    s_mov_b32 m0, 112640
    s_add_u32 s45, s12, 112640
    buffer_load_dwordx4 v2, s[20:23], s45 offen sc1 lds
    s_mov_b32 m0, 113664
    s_add_u32 s45, s12, 113664
    buffer_load_dwordx4 v2, s[20:23], s45 offen sc1 lds
    s_mov_b32 m0, 114688
    s_add_u32 s45, s12, 114688
    buffer_load_dwordx4 v2, s[20:23], s45 offen sc1 lds
    s_mov_b32 m0, 115712
    s_add_u32 s45, s12, 115712
    buffer_load_dwordx4 v2, s[20:23], s45 offen sc1 lds
    s_mov_b32 m0, 116736
    s_add_u32 s45, s12, 116736
    buffer_load_dwordx4 v2, s[20:23], s45 offen sc1 lds
    s_mov_b32 m0, 117760
    s_add_u32 s45, s12, 117760
    buffer_load_dwordx4 v2, s[20:23], s45 offen sc1 lds
    s_mov_b32 m0, 118784
    s_add_u32 s45, s12, 118784
    buffer_load_dwordx4 v2, s[20:23], s45 offen sc1 lds
    s_mov_b32 m0, 119808
    s_add_u32 s45, s13, 110592
    buffer_load_dwordx4 v2, s[20:23], s45 offen sc1 lds
    s_mov_b32 m0, 120832
    s_add_u32 s45, s13, 111616
    buffer_load_dwordx4 v2, s[20:23], s45 offen sc1 lds
    s_mov_b32 m0, 121856
    s_add_u32 s45, s13, 112640
    buffer_load_dwordx4 v2, s[20:23], s45 offen sc1 lds
    s_mov_b32 m0, 122880
    s_add_u32 s45, s13, 113664
    buffer_load_dwordx4 v2, s[20:23], s45 offen sc1 lds
    s_mov_b32 m0, 123904
    s_add_u32 s45, s13, 114688
    buffer_load_dwordx4 v2, s[20:23], s45 offen sc1 lds
    s_mov_b32 m0, 124928
    s_add_u32 s45, s13, 115712
    buffer_load_dwordx4 v2, s[20:23], s45 offen sc1 lds
    s_mov_b32 m0, 125952
    s_add_u32 s45, s13, 116736
    buffer_load_dwordx4 v2, s[20:23], s45 offen sc1 lds
    s_mov_b32 m0, 126976
    s_add_u32 s45, s13, 117760
    buffer_load_dwordx4 v2, s[20:23], s45 offen sc1 lds
    s_mov_b32 m0, 128000
    s_add_u32 s45, s13, 118784
    buffer_load_dwordx4 v2, s[20:23], s45 offen sc1 lds
    s_mov_b32 m0, 129024
    s_add_u32 s45, s14, 110592
    buffer_load_dwordx4 v2, s[20:23], s45 offen sc1 lds
    s_mov_b32 m0, 130048
    s_add_u32 s45, s14, 111616
    buffer_load_dwordx4 v2, s[20:23], s45 offen sc1 lds
L2_lw1:
    s_sleep 2
    ds_read_b32 v8, v6 offset:4
    s_waitcnt lgkmcnt(0)
    v_readfirstlane_b32 s44, v8
    s_nop 3
    s_cmp_lt_u32 s44, 512
    s_cbranch_scc1 L2_lw1

    s_mov_b32 m0, 131072
    s_add_u32 s45, s14, 112640
    buffer_load_dwordx4 v2, s[20:23], s45 offen sc1 lds
    s_mov_b32 m0, 132096
    s_add_u32 s45, s14, 113664
    buffer_load_dwordx4 v2, s[20:23], s45 offen sc1 lds
    s_mov_b32 m0, 133120
    s_add_u32 s45, s14, 114688
    buffer_load_dwordx4 v2, s[20:23], s45 offen sc1 lds
    s_mov_b32 m0, 134144
    s_add_u32 s45, s14, 115712
    buffer_load_dwordx4 v2, s[20:23], s45 offen sc1 lds
    s_mov_b32 m0, 135168
    s_add_u32 s45, s14, 116736
    buffer_load_dwordx4 v2, s[20:23], s45 offen sc1 lds
    s_mov_b32 m0, 136192
    s_add_u32 s45, s14, 117760
    buffer_load_dwordx4 v2, s[20:23], s45 offen sc1 lds
    s_mov_b32 m0, 137216
    s_add_u32 s45, s14, 118784
    buffer_load_dwordx4 v2, s[20:23], s45 offen sc1 lds
    s_mov_b32 m0, 138240
    s_add_u32 s45, s15, 110592
    buffer_load_dwordx4 v2, s[20:23], s45 offen sc1 lds
    s_mov_b32 m0, 139264
    s_add_u32 s45, s15, 111616
    buffer_load_dwordx4 v2, s[20:23], s45 offen sc1 lds
    s_mov_b32 m0, 140288
    s_add_u32 s45, s15, 112640
    buffer_load_dwordx4 v2, s[20:23], s45 offen sc1 lds
    s_mov_b32 m0, 141312
    s_add_u32 s45, s15, 113664
    buffer_load_dwordx4 v2, s[20:23], s45 offen sc1 lds
    s_mov_b32 m0, 142336
    s_add_u32 s45, s15, 114688
    buffer_load_dwordx4 v2, s[20:23], s45 offen sc1 lds
    s_mov_b32 m0, 143360
    s_add_u32 s45, s15, 115712
    buffer_load_dwordx4 v2, s[20:23], s45 offen sc1 lds
    s_mov_b32 m0, 144384
    s_add_u32 s45, s15, 116736
    buffer_load_dwordx4 v2, s[20:23], s45 offen sc1 lds
    s_mov_b32 m0, 145408
    s_add_u32 s45, s15, 117760
    buffer_load_dwordx4 v2, s[20:23], s45 offen sc1 lds
    s_mov_b32 m0, 146432
    s_add_u32 s45, s15, 118784
    buffer_load_dwordx4 v2, s[20:23], s45 offen sc1 lds
    s_waitcnt vmcnt(0)
    ds_write_b32 v6, v15 offset:8
L2_end:
    s_endpgm
.section .rodata,"a"
.p2align 6
.amdhsa_kernel proj_kernel
  .amdhsa_next_free_vgpr 256
  .amdhsa_next_free_sgpr 64
  .amdhsa_accum_offset 256
  .amdhsa_group_segment_fixed_size 0
  .amdhsa_kernarg_size 96
  .amdhsa_user_sgpr_count 2
  .amdhsa_user_sgpr_kernarg_segment_ptr 1
  .amdhsa_system_sgpr_workgroup_id_x 1
.end_amdhsa_kernel
.p2align 6
.amdhsa_kernel attn_kernel
  .amdhsa_next_free_vgpr 168
  .amdhsa_next_free_sgpr 64
  .amdhsa_accum_offset 168
  .amdhsa_group_segment_fixed_size 0
  .amdhsa_kernarg_size 96
  .amdhsa_user_sgpr_count 2
  .amdhsa_user_sgpr_kernarg_segment_ptr 1
  .amdhsa_system_sgpr_workgroup_id_x 1
.end_amdhsa_kernel
```
